```python
import torch

def _softmax(x, axis=-1):
    return torch.softmax(x, dim=axis)
def _gelu(x):
    return torch.nn.functional.gelu(x, approximate="tanh")
def _silu(x):
    return torch.nn.functional.silu(x)
def _sigmoid(x):
    return torch.sigmoid(x)
def _layernorm(x, axis=-1, eps=1e-5):
    m = x.mean(dim=axis, keepdim=True)
    v = x.var(dim=axis, keepdim=True, unbiased=False)
    return (x - m) / torch.sqrt(v + eps)
def _scatter_add(tgt, idx, src, axis=0):
    return tgt.clone().index_add_(axis, idx, src)
def _segment_sum(src, seg, n):
    out = torch.zeros((n,) + src.shape[1:], dtype=src.dtype)
    return out.index_add_(0, seg, src)
def _pad(x, pw):
    flat = tuple(v for pair in reversed(pw) for v in pair)
    return torch.nn.functional.pad(x, flat)

kernel_name = 'sequential_preLN__mha_block_cached__mixer_token_mlp__decode'

def setup_inputs():

    _w = (lambda a: (lambda t: t.to(torch.bfloat16) if t.is_floating_point() else t)(torch.as_tensor(a)))
    def _A_setup():
        B, Sq, D = 4, 1, 640
        H, Sk, Dh = 32, 4096, 192
        return {
            "x": _w((lambda *s: torch.randn(*s, dtype=torch.bfloat16) * 0.05)(B, Sq, D)),
            "k_cache": _w((lambda *s: torch.randn(*s, dtype=torch.bfloat16) * 1.6)(B, H, Sk, Dh)),
            "v_cache": _w((lambda *s: torch.randn(*s, dtype=torch.bfloat16) * 0.8)(B, H, Sk, Dh)),
            "wq": _w((lambda *s: torch.randn(*s, dtype=torch.bfloat16) * 1.6)(D, H * Dh) * (D ** -0.5)),
            "wo": _w((lambda *s: torch.randn(*s, dtype=torch.bfloat16) * 0.8)(H * Dh, D) * ((H * Dh) ** -0.5)),
        }
    _A_in = _A_setup()

    def _B_setup():
        B, S, D, F = 4, 1, 640, 1536
        return {
            "x": _w((lambda *s: torch.randn(*s, dtype=torch.bfloat16) * 0.05)(B, S, D)),
            "w1": _w((lambda *s: torch.randn(*s, dtype=torch.bfloat16) * 3.2)(S, F) * (S ** -0.5)),
            "b1": _w((lambda *s: torch.randn(*s, dtype=torch.bfloat16) * 3.2)(F) * 0.02),
            "w2": _w((lambda *s: torch.randn(*s, dtype=torch.bfloat16) * 0.4)(F, S) * (F ** -0.5)),
            "b2": _w((lambda *s: torch.randn(*s, dtype=torch.bfloat16) * 0.4)(S) * 0.02),
        }
    _B_in = _B_setup()

    return {
        "A_x": _A_in["x"],
        "A_k_cache": _A_in["k_cache"],
        "A_v_cache": _A_in["v_cache"],
        "A_wq": _A_in["wq"],
        "A_wo": _A_in["wo"],
        "B_x": _B_in["x"],
        "B_w1": _B_in["w1"],
        "B_b1": _B_in["b1"],
        "B_w2": _B_in["w2"],
        "B_b2": _B_in["b2"],
    }

def reference(A_x, A_k_cache, A_v_cache, A_wq, A_wo, B_x, B_w1, B_b1, B_w2, B_b2):
    def _A_ref(x, k_cache, v_cache, wq, wo):
        B, Sq, D = x.shape
        H, Dh = 32, 192
        q = (lambda x, *d: x.permute(*d))((x @ wq).reshape(B, Sq, H, Dh), 0, 2, 1, 3)
        scores = torch.einsum("bhqd,bhkd->bhqk", q, k_cache) * (Dh ** -0.5)
        p = _softmax(scores, axis=-1)
        o = torch.einsum("bhqk,bhkd->bhqd", p, v_cache)
        return (lambda x, *d: x.permute(*d))(o, 0, 2, 1, 3).reshape(B, Sq, H * Dh) @ wo

    def _B_ref(x, w1, b1, w2, b2):
        B, S, D = x.shape
        h = _layernorm(x, axis=-1)
        u = torch.einsum("bsd,sf->bdf", h, w1) + b1
        u = _gelu(u)
        y = torch.einsum("bdf,fs->bds", u, w2) + b2
        return (lambda x, *d: x.permute(*d))(y, 0, 2, 1)

    x = A_x
    h = x + _A_ref(_layernorm(x, axis=-1), A_k_cache, A_v_cache, A_wq, A_wo)
    h2 = h + _B_ref(_layernorm(h, axis=-1), B_w1, B_b1, B_w2, B_b2)
    return h2
```

```asm
; @launch grid=(256,1,1) block=(512,1,1) lds=82048
.amdgcn_target "amdgcn-amd-amdhsa--gfx950"
.text
.globl sequential_preLN__mha_block_cached__mixer_token_mlp__decode_kernel
.p2align 8
.type sequential_preLN__mha_block_cached__mixer_token_mlp__decode_kernel,@function
sequential_preLN__mha_block_cached__mixer_token_mlp__decode_kernel:
    s_cmp_ge_u32 s2, 256
    s_cbranch_scc1 L_end
    s_load_dwordx2 s[40:41], s[0:1], 24
    s_load_dwordx2 s[52:53], s[0:1], 0
    s_load_dwordx2 s[32:33], s[0:1], 8
    s_load_dwordx2 s[28:29], s[0:1], 96
    v_lshrrev_b32 v1, 6, v0
    v_and_b32 v0, 63, v0
    v_readfirstlane_b32 s3, v1
    s_lshr_b32 s61, s2, 6
    s_and_b32 s101, s2, 63
    s_lshl2_add_u32 s77, s101, s61
    s_mul_i32 s76, s77, 1366
    s_lshr_b32 s76, s76, 16
    s_mul_i32 s66, s76, 48
    s_sub_u32 s77, s77, s66
    v_lshrrev_b32 v74, 4, v0
    v_and_b32 v75, 15, v0
    v_mul_u32_u24 v64, 49152, v74
    v_lshl_add_u32 v64, v75, 4, v64
    s_lshl3_add_u32 s66, s76, s3
    s_mul_i32 s79, s66, 196608
    s_lshl_b32 s67, s77, 8
    s_add_u32 s79, s79, s67
    s_mov_b32 s42, 7864320
    s_mov_b32 s43, 0x20000
    v_lshlrev_b32 v65, 4, v0
    v_lshlrev_b32 v66, 2, v0
    s_mul_i32 s78, s3, 1280
    s_lshl_b32 s70, s76, 8
    s_add_u32 s70, s70, s78
    s_movk_i32 s54, 5120
    s_mov_b32 s55, s43
    s_cmp_ge_u32 s3, 4
    s_waitcnt lgkmcnt(0)
    s_cbranch_scc1 L_nox
    buffer_load_dwordx4 v[20:23], v65, s[52:55], s78 offen
    buffer_load_dword v24, v66, s[52:55], s78 offen offset:1024
    buffer_load_dword v25, v66, s[52:55], s70 offen
L_nox:
    buffer_load_dwordx4 a[0:3], v64, s[40:43], s79 offen nt
    s_add_u32 s79, s79, 12288
    buffer_load_dwordx4 a[4:7], v64, s[40:43], s79 offen nt
    s_add_u32 s79, s79, 12288
    buffer_load_dwordx4 a[8:11], v64, s[40:43], s79 offen nt
    s_add_u32 s79, s79, 12288
    buffer_load_dwordx4 a[12:15], v64, s[40:43], s79 offen nt
    s_load_dwordx2 s[36:37], s[0:1], 16
    s_load_dwordx2 s[44:45], s[0:1], 32
    s_load_dwordx4 s[16:19], s[0:1], 48
    s_load_dwordx4 s[20:23], s[0:1], 64
    s_load_dwordx2 s[24:25], s[0:1], 80
    s_load_dwordx2 s[96:97], s[28:29], 393216
    v_lshrrev_b32 v1, 3, v0
    v_mul_u32_u24 v1, 384, v1
    v_and_b32 v72, 7, v0
    v_lshl_add_u32 v1, v72, 4, v1
    s_and_b32 s68, s2, 7
    s_bfe_u32 s66, s2, 0x20003
    s_lshl2_add_u32 s60, s68, s66
    s_bfe_u32 s62, s2, 0x10005
    s_lshl1_add_u32 s63, s60, s62
    s_lshl_b32 s66, s61, 6
    s_add_u32 s66, s66, s63
    s_lshl3_add_u32 s66, s66, s3
    s_mul_i32 s14, s66, 98304
    s_add_u32 s15, s14, 98304
    s_mul_i32 s67, s3, 7
    s_mul_i32 s68, s68, 21
    s_add_u32 s67, s67, s68
    s_lshr_b32 s68, s2, 3
    s_mul_i32 s68, s68, 11
    s_add_u32 s67, s67, s68
    s_and_b32 s67, s67, 31
    s_mul_i32 s67, s67, 3072
    s_add_u32 s64, s14, s67
    s_mov_b32 s65, s64
    s_mov_b32 s34, 201326592
    s_mov_b32 s35, 0x20000
    buffer_load_dwordx4 v[76:79], v1, s[32:35], s64 offen offset:0 nt
    buffer_load_dwordx4 v[80:83], v1, s[32:35], s64 offen offset:128 nt
    buffer_load_dwordx4 v[84:87], v1, s[32:35], s64 offen offset:256 nt
    s_add_u32 s64, s64, 3072
    s_cmp_eq_u32 s64, s15
    s_cselect_b32 s64, s14, s64
    v_mul_u32_u24 v2, 768, v74
    v_lshl_add_u32 v2, v75, 4, v2
    v_lshrrev_b32 v7, 1, v74
    v_lshl_add_u32 v7, v7, 2, v74
    v_mul_u32_u24 v7, 1280, v7
    v_lshl_add_u32 v7, v75, 4, v7
    v_and_b32 v73, 1, v0
    v_lshlrev_b32 v73, 4, v73
    v_mov_b32 v67, 0xffff
    v_lshlrev_b32 v73, v73, v67
    s_mov_b32 s72, 0x03030303
    s_mov_b32 s73, 0x03030303
    v_cndmask_b32 v3, 0, v73, s[72:73]
    s_lshl_b64 s[72:73], s[72:73], 2
    v_cndmask_b32 v4, 0, v73, s[72:73]
    s_lshl_b64 s[72:73], s[72:73], 2
    v_cndmask_b32 v5, 0, v73, s[72:73]
    s_lshl_b64 s[72:73], s[72:73], 2
    v_cndmask_b32 v6, 0, v73, s[72:73]
    s_mov_b32 s38, 201326592
    s_mov_b32 s39, 0x20000
    s_mov_b32 s46, 7864320
    s_mov_b32 s47, 0x20000
    s_mov_b32 s48, s28
    s_mov_b32 s49, s29
    s_mov_b32 s50, 1015808
    s_mov_b32 s51, 0x20000
    v_lshrrev_b32 v71, 5, v0
    v_lshlrev_b32 v71, 9, v71
    v_lshl_add_u32 v71, v75, 5, v71
    v_and_b32 v72, 1, v74
    v_lshl_add_u32 v71, v72, 4, v71
    s_lshl_b32 s66, s3, 11
    v_add_u32 v71, s66, v71
    v_bfe_u32 v70, v0, 3, 1
    v_lshlrev_b32 v70, 8, v70
    v_lshl_add_u32 v70, v74, 3, v70
    s_lshl_b32 s66, s3, 5
    v_add_u32 v70, s66, v70
    s_mov_b32 s74, 0x01000100
    s_mov_b32 s75, 0x03020302
    s_lshl_b32 s66, s61, 6
    s_add_u32 s66, s66, s63
    s_mul_i32 s57, s66, 1280
    s_lshl_b32 s66, s66, 7
    s_add_u32 s56, s66, 458752
    s_mul_i32 s30, s60, 192
    s_mul_i32 s31, s3, 24
    s_add_u32 s30, s30, s31
    s_mul_i32 s30, s30, 1280
    s_sub_u32 s101, s101, s61
    s_cmp_eq_u32 s101, 60
    s_cselect_b32 s101, 1, 0
    s_cmp_ge_u32 s3, 4
    s_cbranch_scc1 L_pathH
    v_mov_b32 v26, 0
    v_mov_b32 v27, 0
    v_mov_b32 v28, 0x3f803f80
    s_lshl_b32 s66, s3, 8
    v_add_u32 v66, s66, v66
    s_waitcnt vmcnt(7)
    v_dot2c_f32_bf16 v26, v20, v28
    v_dot2c_f32_bf16 v27, v20, v20
    v_dot2c_f32_bf16 v26, v21, v28
    v_dot2c_f32_bf16 v27, v21, v21
    v_dot2c_f32_bf16 v26, v22, v28
    v_dot2c_f32_bf16 v27, v22, v22
    v_dot2c_f32_bf16 v26, v23, v28
    v_dot2c_f32_bf16 v27, v23, v23
    v_dot2c_f32_bf16 v26, v24, v28
    v_dot2c_f32_bf16 v27, v24, v24
    v_lshlrev_b32 v30, 16, v25
    v_and_b32 v31, 0xffff0000, v25
    v_mov_b32 v29, 0x3acccccd
    s_nop 0
    v_add_f32_dpp v26, v26, v26 quad_perm:[1,0,3,2] row_mask:0xf bank_mask:0xf
    v_add_f32_dpp v27, v27, v27 quad_perm:[1,0,3,2] row_mask:0xf bank_mask:0xf
    s_nop 0
    v_add_f32_dpp v26, v26, v26 quad_perm:[2,3,0,1] row_mask:0xf bank_mask:0xf
    v_add_f32_dpp v27, v27, v27 quad_perm:[2,3,0,1] row_mask:0xf bank_mask:0xf
    s_nop 0
    v_add_f32_dpp v26, v26, v26 row_half_mirror row_mask:0xf bank_mask:0xf
    v_add_f32_dpp v27, v27, v27 row_half_mirror row_mask:0xf bank_mask:0xf
    s_nop 0
    v_add_f32_dpp v26, v26, v26 row_mirror row_mask:0xf bank_mask:0xf
    v_add_f32_dpp v27, v27, v27 row_mirror row_mask:0xf bank_mask:0xf
    s_nop 0
    v_add_f32_dpp v26, v26, v26 row_bcast:15 row_mask:0xa bank_mask:0xf
    v_add_f32_dpp v27, v27, v27 row_bcast:15 row_mask:0xa bank_mask:0xf
    s_nop 0
    v_add_f32_dpp v26, v26, v26 row_bcast:31 row_mask:0xc bank_mask:0xf
    v_add_f32_dpp v27, v27, v27 row_bcast:31 row_mask:0xc bank_mask:0xf
    v_readlane_b32 s66, v26, 63
    v_readlane_b32 s67, v27, 63
    s_nop 0
    v_mul_f32 v26, s66, v29
    v_mul_f32 v27, s67, v29
    v_fma_f32 v27, -v26, v26, v27
    v_max_f32 v27, 0, v27
    v_cvt_pk_bf16_f32 v26, v26, v26
    v_and_b32 v26, 0xffff0000, v26
    v_cvt_pk_bf16_f32 v27, v27, v27
    v_and_b32 v27, 0xffff0000, v27
    v_add_f32 v27, 0x3727c5ac, v27
    v_cvt_pk_bf16_f32 v27, v27, v27
    v_and_b32 v27, 0xffff0000, v27
    v_sqrt_f32 v27, v27
    s_nop 0
    v_cvt_pk_bf16_f32 v27, v27, v27
    v_and_b32 v27, 0xffff0000, v27
    v_rcp_f32 v27, v27
    v_sub_f32 v30, v30, v26
    v_sub_f32 v31, v31, v26
    v_cvt_pk_bf16_f32 v20, v30, v31
    v_lshlrev_b32 v30, 16, v20
    v_and_b32 v31, 0xffff0000, v20
    v_mul_f32 v30, v30, v27
    v_mul_f32 v31, v31, v27
    v_cvt_pk_bf16_f32 v30, v30, v31
    ds_write_b32 v66, v30 offset:14336
    s_waitcnt lgkmcnt(0)
    s_barrier
    ds_read_b64 v[44:45], v70 offset:14336
    ds_read_b64 v[46:47], v70 offset:14848
    buffer_load_dwordx4 v[88:91], v1, s[32:35], s64 offen offset:0 nt
    buffer_load_dwordx4 v[92:95], v1, s[32:35], s64 offen offset:128 nt
    buffer_load_dwordx4 v[96:99], v1, s[32:35], s64 offen offset:256 nt
    s_add_u32 s64, s64, 3072
    s_cmp_eq_u32 s64, s15
    s_cselect_b32 s64, s14, s64
    s_waitcnt lgkmcnt(0)
    v_perm_b32 v36, v44, v44, s74
    v_perm_b32 v37, v44, v44, s75
    v_perm_b32 v38, v45, v45, s74
    v_perm_b32 v39, v45, v45, s75
    v_perm_b32 v40, v46, v46, s74
    v_perm_b32 v41, v46, v46, s75
    v_perm_b32 v42, v47, v47, s74
    v_perm_b32 v43, v47, v47, s75
    v_and_b32 v28, v36, v3
    v_and_b32 v29, v36, v4
    v_and_b32 v30, v36, v5
    v_and_b32 v31, v36, v6
    s_waitcnt vmcnt(6)
    buffer_load_dwordx4 v[100:103], v1, s[32:35], s64 offen offset:0 nt
    buffer_load_dwordx4 v[104:107], v1, s[32:35], s64 offen offset:128 nt
    buffer_load_dwordx4 v[108:111], v1, s[32:35], s64 offen offset:256 nt
    s_add_u32 s64, s64, 3072
    s_cmp_eq_u32 s64, s15
    s_cselect_b32 s64, s14, s64
    v_and_b32 v32, v40, v3
    v_and_b32 v33, v40, v4
    v_and_b32 v34, v40, v5
    v_and_b32 v35, v40, v6
    v_mfma_f32_16x16x32_bf16 v[52:55], v[28:31], a[0:3], 0
    v_and_b32 v28, v37, v3
    v_and_b32 v29, v37, v4
    v_and_b32 v30, v37, v5
    v_and_b32 v31, v37, v6
    v_mfma_f32_16x16x32_bf16 v[56:59], v[32:35], a[0:3], 0
    v_and_b32 v32, v41, v3
    v_and_b32 v33, v41, v4
    v_and_b32 v34, v41, v5
    v_and_b32 v35, v41, v6
    v_mfma_f32_16x16x32_bf16 v[52:55], v[28:31], a[4:7], v[52:55]
    v_and_b32 v28, v38, v3
    v_and_b32 v29, v38, v4
    v_and_b32 v30, v38, v5
    v_and_b32 v31, v38, v6
    v_mfma_f32_16x16x32_bf16 v[56:59], v[32:35], a[4:7], v[56:59]
    v_and_b32 v32, v42, v3
    v_and_b32 v33, v42, v4
    v_and_b32 v34, v42, v5
    v_and_b32 v35, v42, v6
    v_mfma_f32_16x16x32_bf16 v[52:55], v[28:31], a[8:11], v[52:55]
    v_and_b32 v28, v39, v3
    v_and_b32 v29, v39, v4
    v_and_b32 v30, v39, v5
    v_and_b32 v31, v39, v6
    v_mfma_f32_16x16x32_bf16 v[56:59], v[32:35], a[8:11], v[56:59]
    v_and_b32 v32, v43, v3
    v_and_b32 v33, v43, v4
    v_and_b32 v34, v43, v5
    v_and_b32 v35, v43, v6
    v_mfma_f32_16x16x32_bf16 v[52:55], v[28:31], a[12:15], v[52:55]
    s_nop 0
    v_mfma_f32_16x16x32_bf16 v[56:59], v[32:35], a[12:15], v[56:59]
    s_mul_i32 s98, s96, 0x9E3779B1
    s_add_u32 s98, s98, 0x7F4A7C15
    s_xor_b32 s99, s97, s98
    s_mul_i32 s99, s99, 0x85EBCA6B
    s_add_u32 s99, s99, 0x27D4EB2F
    s_nop 2
    ds_write_b128 v71, v[52:55] offset:16384
    ds_write_b128 v71, v[56:59] offset:17408
    s_waitcnt lgkmcnt(0)
    s_barrier
    s_cmp_ge_u32 s76, 5
    s_cbranch_scc1 L_qpub_done
    s_cmp_ge_u32 s3, 2
    s_cbranch_scc1 L_qpub_done
    s_lshl_b32 s66, s3, 10
    v_add_u32 v72, s66, v65
    ds_read_b128 v[20:23], v72 offset:16384
    ds_read_b128 v[24:27], v72 offset:18432
    ds_read_b128 v[28:31], v72 offset:20480
    ds_read_b128 v[32:35], v72 offset:22528
    ds_read_b128 v[36:39], v72 offset:24576
    ds_read_b128 v[40:43], v72 offset:26624
    ds_read_b128 v[44:47], v72 offset:28672
    ds_read_b128 v[48:51], v72 offset:30720
    s_mul_i32 s66, s3, 10
    s_add_u32 s66, s66, s76
    s_mul_i32 s66, s66, 24576
    s_lshl_b32 s67, s77, 9
    s_add_u32 s66, s66, s67
    s_add_u32 s66, s66, 524288
    v_lshrrev_b32 v73, 5, v0
    v_mul_u32_u24 v73, 122368, v73
    v_add_u32 v73, v73, v65
    v_mov_b32 v74, s98
    s_waitcnt lgkmcnt(0)
    v_pk_add_f32 v[20:21], v[20:21], v[36:37]
    v_pk_add_f32 v[22:23], v[22:23], v[38:39]
    v_pk_add_f32 v[24:25], v[24:25], v[40:41]
    v_pk_add_f32 v[26:27], v[26:27], v[42:43]
    v_pk_add_f32 v[28:29], v[28:29], v[44:45]
    v_pk_add_f32 v[30:31], v[30:31], v[46:47]
    v_pk_add_f32 v[32:33], v[32:33], v[48:49]
    v_pk_add_f32 v[34:35], v[34:35], v[50:51]
    v_pk_add_f32 v[20:21], v[20:21], v[28:29]
    v_pk_add_f32 v[22:23], v[22:23], v[30:31]
    v_pk_add_f32 v[24:25], v[24:25], v[32:33]
    v_pk_add_f32 v[26:27], v[26:27], v[34:35]
    v_pk_add_f32 v[20:21], v[20:21], v[24:25]
    v_pk_add_f32 v[22:23], v[22:23], v[26:27]
    s_mov_b32 s67, 0x7060500
    v_perm_b32 v20, v20, v74, s67
    s_mov_b32 s67, 0x7060501
    v_perm_b32 v21, v21, v74, s67
    s_mov_b32 s67, 0x7060502
    v_perm_b32 v22, v22, v74, s67
    s_mov_b32 s67, 0x7060503
    v_perm_b32 v23, v23, v74, s67
    buffer_store_dwordx4 v[20:23], v73, s[48:51], s66 offen sc1
L_qpub_done:
    s_waitcnt vmcnt(8)
    s_waitcnt vmcnt(7)
    s_waitcnt vmcnt(6)
    s_waitcnt vmcnt(5)
    s_waitcnt vmcnt(4)
    s_waitcnt vmcnt(3)
    buffer_load_dwordx4 v[112:115], v1, s[32:35], s64 offen offset:0 nt
    s_waitcnt vmcnt(3)
    buffer_load_dwordx4 v[116:119], v1, s[32:35], s64 offen offset:128 nt
    s_waitcnt vmcnt(3)
    buffer_load_dwordx4 v[120:123], v1, s[32:35], s64 offen offset:256 nt
    s_add_u32 s64, s64, 3072
    s_cmp_eq_u32 s64, s15
    s_cselect_b32 s64, s14, s64
    s_waitcnt vmcnt(3)
    buffer_load_dwordx4 v[124:127], v1, s[32:35], s64 offen offset:0 nt
    s_waitcnt vmcnt(3)
    buffer_load_dwordx4 v[128:131], v1, s[32:35], s64 offen offset:128 nt
    s_waitcnt vmcnt(3)
    buffer_load_dwordx4 v[132:135], v1, s[32:35], s64 offen offset:256 nt
    s_add_u32 s64, s64, 3072
    s_cmp_eq_u32 s64, s15
    s_cselect_b32 s64, s14, s64
    s_waitcnt vmcnt(3)
    buffer_load_dwordx4 a[16:19], v1, s[32:35], s64 offen offset:0 nt
    s_waitcnt vmcnt(3)
    buffer_load_dwordx4 a[20:23], v1, s[32:35], s64 offen offset:128 nt
    s_waitcnt vmcnt(3)
    buffer_load_dwordx4 a[24:27], v1, s[32:35], s64 offen offset:256 nt
    s_add_u32 s64, s64, 3072
    s_cmp_eq_u32 s64, s15
    s_cselect_b32 s64, s14, s64
    s_waitcnt vmcnt(3)
    buffer_load_dwordx4 a[28:31], v1, s[32:35], s64 offen offset:0 nt
    s_waitcnt vmcnt(3)
    buffer_load_dwordx4 a[32:35], v1, s[32:35], s64 offen offset:128 nt
    s_waitcnt vmcnt(3)
    buffer_load_dwordx4 a[36:39], v1, s[32:35], s64 offen offset:256 nt
    s_add_u32 s64, s64, 3072
    s_cmp_eq_u32 s64, s15
    s_cselect_b32 s64, s14, s64
    s_waitcnt vmcnt(3)
    buffer_load_dwordx4 a[40:43], v1, s[32:35], s64 offen offset:0 nt
    s_waitcnt vmcnt(3)
    buffer_load_dwordx4 a[44:47], v1, s[32:35], s64 offen offset:128 nt
    s_waitcnt vmcnt(3)
    buffer_load_dwordx4 a[48:51], v1, s[32:35], s64 offen offset:256 nt
    s_add_u32 s64, s64, 3072
    s_cmp_eq_u32 s64, s15
    s_cselect_b32 s64, s14, s64
    s_waitcnt vmcnt(3)
    buffer_load_dwordx4 a[52:55], v1, s[32:35], s64 offen offset:0 nt
    s_waitcnt vmcnt(3)
    buffer_load_dwordx4 a[56:59], v1, s[32:35], s64 offen offset:128 nt
    s_waitcnt vmcnt(3)
    buffer_load_dwordx4 a[60:63], v1, s[32:35], s64 offen offset:256 nt
    s_add_u32 s64, s64, 3072
    s_cmp_eq_u32 s64, s15
    s_cselect_b32 s64, s14, s64
    s_branch L_qbar
L_pathH:
    buffer_load_dwordx4 v[88:91], v1, s[32:35], s64 offen offset:0 nt
    buffer_load_dwordx4 v[92:95], v1, s[32:35], s64 offen offset:128 nt
    buffer_load_dwordx4 v[96:99], v1, s[32:35], s64 offen offset:256 nt
    s_add_u32 s64, s64, 3072
    s_cmp_eq_u32 s64, s15
    s_cselect_b32 s64, s14, s64
    v_mov_b32 v72, 0
    v_mov_b32 v73, 0
    ds_write_b64 v72, v[72:73] offset:13056
    s_waitcnt lgkmcnt(0)
    s_barrier
    ds_read_b64 v[44:45], v70 offset:14336
    ds_read_b64 v[46:47], v70 offset:14848
    s_waitcnt lgkmcnt(0)
    v_perm_b32 v36, v44, v44, s74
    v_perm_b32 v37, v44, v44, s75
    v_perm_b32 v38, v45, v45, s74
    v_perm_b32 v39, v45, v45, s75
    v_perm_b32 v40, v46, v46, s74
    v_perm_b32 v41, v46, v46, s75
    v_perm_b32 v42, v47, v47, s74
    v_perm_b32 v43, v47, v47, s75
    v_and_b32 v28, v36, v3
    v_and_b32 v29, v36, v4
    v_and_b32 v30, v36, v5
    v_and_b32 v31, v36, v6
    s_waitcnt vmcnt(6)
    buffer_load_dwordx4 v[100:103], v1, s[32:35], s64 offen offset:0 nt
    buffer_load_dwordx4 v[104:107], v1, s[32:35], s64 offen offset:128 nt
    buffer_load_dwordx4 v[108:111], v1, s[32:35], s64 offen offset:256 nt
    s_add_u32 s64, s64, 3072
    s_cmp_eq_u32 s64, s15
    s_cselect_b32 s64, s14, s64
    v_and_b32 v32, v40, v3
    v_and_b32 v33, v40, v4
    v_and_b32 v34, v40, v5
    v_and_b32 v35, v40, v6
    v_mfma_f32_16x16x32_bf16 v[52:55], v[28:31], a[0:3], 0
    v_and_b32 v28, v37, v3
    v_and_b32 v29, v37, v4
    v_and_b32 v30, v37, v5
    v_and_b32 v31, v37, v6
    v_mfma_f32_16x16x32_bf16 v[56:59], v[32:35], a[0:3], 0
    v_and_b32 v32, v41, v3
    v_and_b32 v33, v41, v4
    v_and_b32 v34, v41, v5
    v_and_b32 v35, v41, v6
    v_mfma_f32_16x16x32_bf16 v[52:55], v[28:31], a[4:7], v[52:55]
    v_and_b32 v28, v38, v3
    v_and_b32 v29, v38, v4
    v_and_b32 v30, v38, v5
    v_and_b32 v31, v38, v6
    v_mfma_f32_16x16x32_bf16 v[56:59], v[32:35], a[4:7], v[56:59]
    v_and_b32 v32, v42, v3
    v_and_b32 v33, v42, v4
    v_and_b32 v34, v42, v5
    v_and_b32 v35, v42, v6
    v_mfma_f32_16x16x32_bf16 v[52:55], v[28:31], a[8:11], v[52:55]
    v_and_b32 v28, v39, v3
    v_and_b32 v29, v39, v4
    v_and_b32 v30, v39, v5
    v_and_b32 v31, v39, v6
    v_mfma_f32_16x16x32_bf16 v[56:59], v[32:35], a[8:11], v[56:59]
    v_and_b32 v32, v43, v3
    v_and_b32 v33, v43, v4
    v_and_b32 v34, v43, v5
    v_and_b32 v35, v43, v6
    v_mfma_f32_16x16x32_bf16 v[52:55], v[28:31], a[12:15], v[52:55]
    s_nop 0
    v_mfma_f32_16x16x32_bf16 v[56:59], v[32:35], a[12:15], v[56:59]
    s_mul_i32 s98, s96, 0x9E3779B1
    s_add_u32 s98, s98, 0x7F4A7C15
    s_xor_b32 s99, s97, s98
    s_mul_i32 s99, s99, 0x85EBCA6B
    s_add_u32 s99, s99, 0x27D4EB2F
    s_nop 2
    ds_write_b128 v71, v[52:55] offset:16384
    ds_write_b128 v71, v[56:59] offset:17408
    s_waitcnt lgkmcnt(0)
    s_barrier
    s_cmp_eq_u32 s3, 4
    s_cbranch_scc1 L_qpoll
    s_waitcnt vmcnt(8)
    s_waitcnt vmcnt(7)
    s_waitcnt vmcnt(6)
    s_waitcnt vmcnt(5)
    s_waitcnt vmcnt(4)
    s_waitcnt vmcnt(3)
    buffer_load_dwordx4 v[112:115], v1, s[32:35], s64 offen offset:0 nt
    s_waitcnt vmcnt(3)
    buffer_load_dwordx4 v[116:119], v1, s[32:35], s64 offen offset:128 nt
    s_waitcnt vmcnt(3)
    buffer_load_dwordx4 v[120:123], v1, s[32:35], s64 offen offset:256 nt
    s_add_u32 s64, s64, 3072
    s_cmp_eq_u32 s64, s15
    s_cselect_b32 s64, s14, s64
    s_waitcnt vmcnt(3)
    buffer_load_dwordx4 v[124:127], v1, s[32:35], s64 offen offset:0 nt
    s_waitcnt vmcnt(3)
    buffer_load_dwordx4 v[128:131], v1, s[32:35], s64 offen offset:128 nt
    s_waitcnt vmcnt(3)
    buffer_load_dwordx4 v[132:135], v1, s[32:35], s64 offen offset:256 nt
    s_add_u32 s64, s64, 3072
    s_cmp_eq_u32 s64, s15
    s_cselect_b32 s64, s14, s64
    s_waitcnt vmcnt(3)
    buffer_load_dwordx4 a[16:19], v1, s[32:35], s64 offen offset:0 nt
    s_waitcnt vmcnt(3)
    buffer_load_dwordx4 a[20:23], v1, s[32:35], s64 offen offset:128 nt
    s_waitcnt vmcnt(3)
    buffer_load_dwordx4 a[24:27], v1, s[32:35], s64 offen offset:256 nt
    s_add_u32 s64, s64, 3072
    s_cmp_eq_u32 s64, s15
    s_cselect_b32 s64, s14, s64
    s_waitcnt vmcnt(3)
    buffer_load_dwordx4 a[28:31], v1, s[32:35], s64 offen offset:0 nt
    s_waitcnt vmcnt(3)
    buffer_load_dwordx4 a[32:35], v1, s[32:35], s64 offen offset:128 nt
    s_waitcnt vmcnt(3)
    buffer_load_dwordx4 a[36:39], v1, s[32:35], s64 offen offset:256 nt
    s_add_u32 s64, s64, 3072
    s_cmp_eq_u32 s64, s15
    s_cselect_b32 s64, s14, s64
    s_waitcnt vmcnt(3)
    buffer_load_dwordx4 a[40:43], v1, s[32:35], s64 offen offset:0 nt
    s_waitcnt vmcnt(3)
    buffer_load_dwordx4 a[44:47], v1, s[32:35], s64 offen offset:128 nt
    s_waitcnt vmcnt(3)
    buffer_load_dwordx4 a[48:51], v1, s[32:35], s64 offen offset:256 nt
    s_add_u32 s64, s64, 3072
    s_cmp_eq_u32 s64, s15
    s_cselect_b32 s64, s14, s64
    s_waitcnt vmcnt(3)
    buffer_load_dwordx4 a[52:55], v1, s[32:35], s64 offen offset:0 nt
    s_waitcnt vmcnt(3)
    buffer_load_dwordx4 a[56:59], v1, s[32:35], s64 offen offset:128 nt
    s_waitcnt vmcnt(3)
    buffer_load_dwordx4 a[60:63], v1, s[32:35], s64 offen offset:256 nt
    s_add_u32 s64, s64, 3072
    s_cmp_eq_u32 s64, s15
    s_cselect_b32 s64, s14, s64
    s_branch L_qbar
L_qpoll:
    v_mov_b32 v52, -1
    v_mov_b32 v53, -1
    v_mov_b32 v54, -1
    v_mov_b32 v55, -1
    buffer_store_dwordx4 v[52:55], v65, s[48:51], s57 offen sc1
    s_mov_b64 exec, 0xffff
    buffer_store_dwordx4 v[52:55], v65, s[48:51], s57 offen offset:1024 sc1
    s_mov_b64 exec, -1
    v_min_u32 v73, 47, v0
    v_lshlrev_b32 v73, 4, v73
    s_mul_i32 s66, s61, 122880
    s_mul_i32 s67, s60, 768
    s_add_u32 s66, s66, s67
    s_add_u32 s66, s66, 524288
    s_mov_b32 s74, 0
    s_bfe_u32 s70, s98, 0x80000
    s_bfe_u32 s71, s98, 0x80008
    s_bfe_u32 s72, s98, 0x80010
    s_bfe_u32 s73, s98, 0x80018
    buffer_load_dwordx4 v[112:115], v1, s[32:35], s64 offen offset:0 nt
    buffer_load_dwordx4 v[116:119], v1, s[32:35], s64 offen offset:128 nt
    buffer_load_dwordx4 v[120:123], v1, s[32:35], s64 offen offset:256 nt
    s_add_u32 s64, s64, 3072
    s_cmp_eq_u32 s64, s15
    s_cselect_b32 s64, s14, s64
    buffer_load_dwordx4 v[124:127], v1, s[32:35], s64 offen offset:0 nt
    buffer_load_dwordx4 v[128:131], v1, s[32:35], s64 offen offset:128 nt
    buffer_load_dwordx4 v[132:135], v1, s[32:35], s64 offen offset:256 nt
    s_add_u32 s64, s64, 3072
    s_cmp_eq_u32 s64, s15
    s_cselect_b32 s64, s14, s64
    buffer_load_dwordx4 a[16:19], v1, s[32:35], s64 offen offset:0 nt
    buffer_load_dwordx4 a[20:23], v1, s[32:35], s64 offen offset:128 nt
    buffer_load_dwordx4 a[24:27], v1, s[32:35], s64 offen offset:256 nt
    s_add_u32 s64, s64, 3072
    s_cmp_eq_u32 s64, s15
    s_cselect_b32 s64, s14, s64
    buffer_load_dwordx4 a[28:31], v1, s[32:35], s64 offen offset:0 nt
    buffer_load_dwordx4 a[32:35], v1, s[32:35], s64 offen offset:128 nt
    buffer_load_dwordx4 a[36:39], v1, s[32:35], s64 offen offset:256 nt
    s_add_u32 s64, s64, 3072
    s_cmp_eq_u32 s64, s15
    s_cselect_b32 s64, s14, s64
    buffer_load_dwordx4 a[40:43], v1, s[32:35], s64 offen offset:0 nt
    buffer_load_dwordx4 a[44:47], v1, s[32:35], s64 offen offset:128 nt
    buffer_load_dwordx4 a[48:51], v1, s[32:35], s64 offen offset:256 nt
    s_add_u32 s64, s64, 3072
    s_cmp_eq_u32 s64, s15
    s_cselect_b32 s64, s14, s64
    buffer_load_dwordx4 a[52:55], v1, s[32:35], s64 offen offset:0 nt
    buffer_load_dwordx4 a[56:59], v1, s[32:35], s64 offen offset:128 nt
    buffer_load_dwordx4 a[60:63], v1, s[32:35], s64 offen offset:256 nt
    s_add_u32 s64, s64, 3072
    s_cmp_eq_u32 s64, s15
    s_cselect_b32 s64, s14, s64
L_q_retry:
    s_add_u32 s68, s66, 0
    buffer_load_dwordx4 v[20:23], v73, s[48:51], s68 offen sc1
    s_add_u32 s68, s66, 24576
    buffer_load_dwordx4 v[24:27], v73, s[48:51], s68 offen sc1
    s_add_u32 s68, s66, 49152
    buffer_load_dwordx4 v[28:31], v73, s[48:51], s68 offen sc1
    s_add_u32 s68, s66, 73728
    buffer_load_dwordx4 v[32:35], v73, s[48:51], s68 offen sc1
    s_add_u32 s68, s66, 98304
    buffer_load_dwordx4 v[36:39], v73, s[48:51], s68 offen sc1
    s_waitcnt vmcnt(0)
    v_mov_b32 v64, 0
    v_xor_b32 v20, s70, v20
    v_xor_b32 v21, s71, v21
    v_or3_b32 v64, v64, v20, v21
    v_xor_b32 v22, s72, v22
    v_xor_b32 v23, s73, v23
    v_or3_b32 v64, v64, v22, v23
    v_xor_b32 v24, s70, v24
    v_xor_b32 v25, s71, v25
    v_or3_b32 v64, v64, v24, v25
    v_xor_b32 v26, s72, v26
    v_xor_b32 v27, s73, v27
    v_or3_b32 v64, v64, v26, v27
    v_xor_b32 v28, s70, v28
    v_xor_b32 v29, s71, v29
    v_or3_b32 v64, v64, v28, v29
    v_xor_b32 v30, s72, v30
    v_xor_b32 v31, s73, v31
    v_or3_b32 v64, v64, v30, v31
    v_xor_b32 v32, s70, v32
    v_xor_b32 v33, s71, v33
    v_or3_b32 v64, v64, v32, v33
    v_xor_b32 v34, s72, v34
    v_xor_b32 v35, s73, v35
    v_or3_b32 v64, v64, v34, v35
    v_xor_b32 v36, s70, v36
    v_xor_b32 v37, s71, v37
    v_or3_b32 v64, v64, v36, v37
    v_xor_b32 v38, s72, v38
    v_xor_b32 v39, s73, v39
    v_or3_b32 v64, v64, v38, v39
    v_and_b32 v64, 0xff, v64
    v_cmp_ne_u32 vcc, 0, v64
    s_cbranch_vccz L_q_ok
    s_add_u32 s74, s74, 1
    s_cmp_lt_u32 s74, 200000
    s_cbranch_scc1 L_q_retry
L_q_ok:
    v_pk_add_f32 v[20:21], v[20:21], v[24:25]
    v_pk_add_f32 v[22:23], v[22:23], v[26:27]
    v_pk_add_f32 v[20:21], v[20:21], v[28:29]
    v_pk_add_f32 v[22:23], v[22:23], v[30:31]
    v_pk_add_f32 v[20:21], v[20:21], v[32:33]
    v_pk_add_f32 v[22:23], v[22:23], v[34:35]
    v_pk_add_f32 v[20:21], v[20:21], v[36:37]
    v_pk_add_f32 v[22:23], v[22:23], v[38:39]
    v_cvt_pk_bf16_f32 v20, v20, v21
    v_cvt_pk_bf16_f32 v21, v22, v23
    v_lshrrev_b32 v73, 1, v73
    ds_write_b64 v73, v[20:21] offset:12544
    s_waitcnt lgkmcnt(0)
L_qbar:
    v_and_b32 v72, 7, v0
    v_lshlrev_b32 v72, 4, v72
    s_barrier
    ds_read_b128 v[8:11], v72 offset:12544
    ds_read_b128 v[12:15], v72 offset:12672
    ds_read_b128 v[16:19], v72 offset:12800
    s_waitcnt lgkmcnt(0)
    v_mov_b32 v20, 0
    v_dot2c_f32_bf16 v20, v76, v8
    v_dot2c_f32_bf16 v20, v77, v9
    v_dot2c_f32_bf16 v20, v78, v10
    v_dot2c_f32_bf16 v20, v79, v11
    v_dot2c_f32_bf16 v20, v80, v12
    v_dot2c_f32_bf16 v20, v81, v13
    v_dot2c_f32_bf16 v20, v82, v14
    v_dot2c_f32_bf16 v20, v83, v15
    v_dot2c_f32_bf16 v20, v84, v16
    v_dot2c_f32_bf16 v20, v85, v17
    v_dot2c_f32_bf16 v20, v86, v18
    v_dot2c_f32_bf16 v20, v87, v19
    v_mov_b32 v21, 0
    v_dot2c_f32_bf16 v21, v88, v8
    v_dot2c_f32_bf16 v21, v89, v9
    v_add_f32_dpp v20, v20, v20 quad_perm:[1,0,3,2] row_mask:0xf bank_mask:0xf
    v_dot2c_f32_bf16 v21, v90, v10
    v_dot2c_f32_bf16 v21, v91, v11
    v_add_f32_dpp v20, v20, v20 quad_perm:[2,3,0,1] row_mask:0xf bank_mask:0xf
    v_dot2c_f32_bf16 v21, v92, v12
    v_dot2c_f32_bf16 v21, v93, v13
    v_add_f32_dpp v20, v20, v20 row_half_mirror row_mask:0xf bank_mask:0xf
    v_dot2c_f32_bf16 v21, v94, v14
    v_dot2c_f32_bf16 v21, v95, v15
    v_cvt_pk_bf16_f32 v20, v20, v20
    v_dot2c_f32_bf16 v21, v96, v16
    v_and_b32 v20, 0xffff0000, v20
    v_dot2c_f32_bf16 v21, v97, v17
    v_mul_f32 v20, 0x3d93cd3a, v20
    v_dot2c_f32_bf16 v21, v98, v18
    v_cvt_pk_bf16_f32 v20, v20, v20
    v_dot2c_f32_bf16 v21, v99, v19
    v_and_b32 v20, 0xffff0000, v20
    v_mov_b32 v22, 0
    v_dot2c_f32_bf16 v22, v100, v8
    v_dot2c_f32_bf16 v22, v101, v9
    v_add_f32_dpp v21, v21, v21 quad_perm:[1,0,3,2] row_mask:0xf bank_mask:0xf
    v_dot2c_f32_bf16 v22, v102, v10
    v_dot2c_f32_bf16 v22, v103, v11
    v_add_f32_dpp v21, v21, v21 quad_perm:[2,3,0,1] row_mask:0xf bank_mask:0xf
    v_dot2c_f32_bf16 v22, v104, v12
    v_dot2c_f32_bf16 v22, v105, v13
    v_add_f32_dpp v21, v21, v21 row_half_mirror row_mask:0xf bank_mask:0xf
    v_dot2c_f32_bf16 v22, v106, v14
    v_dot2c_f32_bf16 v22, v107, v15
    v_cvt_pk_bf16_f32 v21, v21, v21
    v_dot2c_f32_bf16 v22, v108, v16
    v_and_b32 v21, 0xffff0000, v21
    v_dot2c_f32_bf16 v22, v109, v17
    v_mul_f32 v21, 0x3d93cd3a, v21
    v_dot2c_f32_bf16 v22, v110, v18
    v_cvt_pk_bf16_f32 v21, v21, v21
    v_dot2c_f32_bf16 v22, v111, v19
    v_and_b32 v21, 0xffff0000, v21
    v_mov_b32 v23, 0
    v_dot2c_f32_bf16 v23, v112, v8
    v_dot2c_f32_bf16 v23, v113, v9
    v_add_f32_dpp v22, v22, v22 quad_perm:[1,0,3,2] row_mask:0xf bank_mask:0xf
    v_dot2c_f32_bf16 v23, v114, v10
    v_dot2c_f32_bf16 v23, v115, v11
    v_add_f32_dpp v22, v22, v22 quad_perm:[2,3,0,1] row_mask:0xf bank_mask:0xf
    v_dot2c_f32_bf16 v23, v116, v12
    v_dot2c_f32_bf16 v23, v117, v13
    v_add_f32_dpp v22, v22, v22 row_half_mirror row_mask:0xf bank_mask:0xf
    v_dot2c_f32_bf16 v23, v118, v14
    v_dot2c_f32_bf16 v23, v119, v15
    v_cvt_pk_bf16_f32 v22, v22, v22
    v_dot2c_f32_bf16 v23, v120, v16
    v_and_b32 v22, 0xffff0000, v22
    v_dot2c_f32_bf16 v23, v121, v17
    v_mul_f32 v22, 0x3d93cd3a, v22
    v_dot2c_f32_bf16 v23, v122, v18
    v_cvt_pk_bf16_f32 v22, v22, v22
    v_dot2c_f32_bf16 v23, v123, v19
    v_and_b32 v22, 0xffff0000, v22
    v_mov_b32 v24, 0
    v_dot2c_f32_bf16 v24, v124, v8
    v_dot2c_f32_bf16 v24, v125, v9
    v_add_f32_dpp v23, v23, v23 quad_perm:[1,0,3,2] row_mask:0xf bank_mask:0xf
    v_dot2c_f32_bf16 v24, v126, v10
    v_dot2c_f32_bf16 v24, v127, v11
    v_add_f32_dpp v23, v23, v23 quad_perm:[2,3,0,1] row_mask:0xf bank_mask:0xf
    v_dot2c_f32_bf16 v24, v128, v12
    v_dot2c_f32_bf16 v24, v129, v13
    v_add_f32_dpp v23, v23, v23 row_half_mirror row_mask:0xf bank_mask:0xf
    v_dot2c_f32_bf16 v24, v130, v14
    v_dot2c_f32_bf16 v24, v131, v15
    v_cvt_pk_bf16_f32 v23, v23, v23
    v_dot2c_f32_bf16 v24, v132, v16
    v_and_b32 v23, 0xffff0000, v23
    v_dot2c_f32_bf16 v24, v133, v17
    v_mul_f32 v23, 0x3d93cd3a, v23
    v_dot2c_f32_bf16 v24, v134, v18
    v_cvt_pk_bf16_f32 v23, v23, v23
    v_dot2c_f32_bf16 v24, v135, v19
    v_and_b32 v23, 0xffff0000, v23
    v_mov_b32 v25, 0
    v_accvgpr_read_b32 v52, a16
    v_accvgpr_read_b32 v53, a17
    v_accvgpr_read_b32 v54, a18
    v_accvgpr_read_b32 v55, a19
    v_accvgpr_read_b32 v56, a20
    v_accvgpr_read_b32 v57, a21
    v_accvgpr_read_b32 v58, a22
    v_accvgpr_read_b32 v59, a23
    v_accvgpr_read_b32 v60, a24
    v_accvgpr_read_b32 v61, a25
    v_accvgpr_read_b32 v62, a26
    v_accvgpr_read_b32 v63, a27
    v_dot2c_f32_bf16 v25, v52, v8
    v_dot2c_f32_bf16 v25, v53, v9
    v_add_f32_dpp v24, v24, v24 quad_perm:[1,0,3,2] row_mask:0xf bank_mask:0xf
    v_dot2c_f32_bf16 v25, v54, v10
    v_dot2c_f32_bf16 v25, v55, v11
    v_add_f32_dpp v24, v24, v24 quad_perm:[2,3,0,1] row_mask:0xf bank_mask:0xf
    v_dot2c_f32_bf16 v25, v56, v12
    v_dot2c_f32_bf16 v25, v57, v13
    v_add_f32_dpp v24, v24, v24 row_half_mirror row_mask:0xf bank_mask:0xf
    v_dot2c_f32_bf16 v25, v58, v14
    v_dot2c_f32_bf16 v25, v59, v15
    v_cvt_pk_bf16_f32 v24, v24, v24
    v_dot2c_f32_bf16 v25, v60, v16
    v_and_b32 v24, 0xffff0000, v24
    v_dot2c_f32_bf16 v25, v61, v17
    v_mul_f32 v24, 0x3d93cd3a, v24
    v_dot2c_f32_bf16 v25, v62, v18
    v_cvt_pk_bf16_f32 v24, v24, v24
    v_dot2c_f32_bf16 v25, v63, v19
    v_and_b32 v24, 0xffff0000, v24
    v_mov_b32 v26, 0
    v_accvgpr_read_b32 v52, a28
    v_accvgpr_read_b32 v53, a29
    v_accvgpr_read_b32 v54, a30
    v_accvgpr_read_b32 v55, a31
    v_accvgpr_read_b32 v56, a32
    v_accvgpr_read_b32 v57, a33
    v_accvgpr_read_b32 v58, a34
    v_accvgpr_read_b32 v59, a35
    v_accvgpr_read_b32 v60, a36
    v_accvgpr_read_b32 v61, a37
    v_accvgpr_read_b32 v62, a38
    v_accvgpr_read_b32 v63, a39
    v_dot2c_f32_bf16 v26, v52, v8
    v_dot2c_f32_bf16 v26, v53, v9
    v_add_f32_dpp v25, v25, v25 quad_perm:[1,0,3,2] row_mask:0xf bank_mask:0xf
    v_dot2c_f32_bf16 v26, v54, v10
    v_dot2c_f32_bf16 v26, v55, v11
    v_add_f32_dpp v25, v25, v25 quad_perm:[2,3,0,1] row_mask:0xf bank_mask:0xf
    v_dot2c_f32_bf16 v26, v56, v12
    v_dot2c_f32_bf16 v26, v57, v13
    v_add_f32_dpp v25, v25, v25 row_half_mirror row_mask:0xf bank_mask:0xf
    v_dot2c_f32_bf16 v26, v58, v14
    v_dot2c_f32_bf16 v26, v59, v15
    v_cvt_pk_bf16_f32 v25, v25, v25
    v_dot2c_f32_bf16 v26, v60, v16
    v_and_b32 v25, 0xffff0000, v25
    v_dot2c_f32_bf16 v26, v61, v17
    v_mul_f32 v25, 0x3d93cd3a, v25
    v_dot2c_f32_bf16 v26, v62, v18
    v_cvt_pk_bf16_f32 v25, v25, v25
    v_dot2c_f32_bf16 v26, v63, v19
    v_and_b32 v25, 0xffff0000, v25
    v_mov_b32 v27, 0
    s_waitcnt vmcnt(3)
    buffer_load_dwordx4 v[76:79], v1, s[32:35], s64 offen offset:0 nt
    v_accvgpr_read_b32 v52, a40
    v_accvgpr_read_b32 v53, a41
    v_accvgpr_read_b32 v54, a42
    v_accvgpr_read_b32 v55, a43
    v_accvgpr_read_b32 v56, a44
    v_accvgpr_read_b32 v57, a45
    v_accvgpr_read_b32 v58, a46
    v_accvgpr_read_b32 v59, a47
    v_accvgpr_read_b32 v60, a48
    v_accvgpr_read_b32 v61, a49
    v_accvgpr_read_b32 v62, a50
    v_accvgpr_read_b32 v63, a51
    v_dot2c_f32_bf16 v27, v52, v8
    v_dot2c_f32_bf16 v27, v53, v9
    v_add_f32_dpp v26, v26, v26 quad_perm:[1,0,3,2] row_mask:0xf bank_mask:0xf
    v_dot2c_f32_bf16 v27, v54, v10
    v_dot2c_f32_bf16 v27, v55, v11
    v_add_f32_dpp v26, v26, v26 quad_perm:[2,3,0,1] row_mask:0xf bank_mask:0xf
    v_dot2c_f32_bf16 v27, v56, v12
    v_dot2c_f32_bf16 v27, v57, v13
    v_add_f32_dpp v26, v26, v26 row_half_mirror row_mask:0xf bank_mask:0xf
    v_dot2c_f32_bf16 v27, v58, v14
    v_dot2c_f32_bf16 v27, v59, v15
    v_cvt_pk_bf16_f32 v26, v26, v26
    v_dot2c_f32_bf16 v27, v60, v16
    v_and_b32 v26, 0xffff0000, v26
    v_dot2c_f32_bf16 v27, v61, v17
    v_mul_f32 v26, 0x3d93cd3a, v26
    v_dot2c_f32_bf16 v27, v62, v18
    v_cvt_pk_bf16_f32 v26, v26, v26
    v_dot2c_f32_bf16 v27, v63, v19
    v_and_b32 v26, 0xffff0000, v26
    v_mov_b32 v28, 0
    s_waitcnt vmcnt(3)
    buffer_load_dwordx4 v[80:83], v1, s[32:35], s64 offen offset:128 nt
    s_waitcnt vmcnt(3)
    buffer_load_dwordx4 v[84:87], v1, s[32:35], s64 offen offset:256 nt
    s_add_u32 s64, s64, 3072
    s_cmp_eq_u32 s64, s15
    s_cselect_b32 s64, s14, s64
    s_waitcnt vmcnt(3)
    buffer_load_dwordx4 v[88:91], v1, s[32:35], s64 offen offset:0 nt
    v_accvgpr_read_b32 v52, a52
    v_accvgpr_read_b32 v53, a53
    v_accvgpr_read_b32 v54, a54
    v_accvgpr_read_b32 v55, a55
    v_accvgpr_read_b32 v56, a56
    v_accvgpr_read_b32 v57, a57
    v_accvgpr_read_b32 v58, a58
    v_accvgpr_read_b32 v59, a59
    v_accvgpr_read_b32 v60, a60
    v_accvgpr_read_b32 v61, a61
    v_accvgpr_read_b32 v62, a62
    v_accvgpr_read_b32 v63, a63
    v_dot2c_f32_bf16 v28, v52, v8
    v_dot2c_f32_bf16 v28, v53, v9
    v_add_f32_dpp v27, v27, v27 quad_perm:[1,0,3,2] row_mask:0xf bank_mask:0xf
    v_dot2c_f32_bf16 v28, v54, v10
    v_dot2c_f32_bf16 v28, v55, v11
    v_add_f32_dpp v27, v27, v27 quad_perm:[2,3,0,1] row_mask:0xf bank_mask:0xf
    v_dot2c_f32_bf16 v28, v56, v12
    v_dot2c_f32_bf16 v28, v57, v13
    v_add_f32_dpp v27, v27, v27 row_half_mirror row_mask:0xf bank_mask:0xf
    v_dot2c_f32_bf16 v28, v58, v14
    v_dot2c_f32_bf16 v28, v59, v15
    v_cvt_pk_bf16_f32 v27, v27, v27
    v_dot2c_f32_bf16 v28, v60, v16
    v_and_b32 v27, 0xffff0000, v27
    v_dot2c_f32_bf16 v28, v61, v17
    v_mul_f32 v27, 0x3d93cd3a, v27
    v_dot2c_f32_bf16 v28, v62, v18
    v_cvt_pk_bf16_f32 v27, v27, v27
    v_dot2c_f32_bf16 v28, v63, v19
    v_and_b32 v27, 0xffff0000, v27
    v_mov_b32 v29, 0
    s_waitcnt vmcnt(3)
    buffer_load_dwordx4 v[92:95], v1, s[32:35], s64 offen offset:128 nt
    s_waitcnt vmcnt(3)
    buffer_load_dwordx4 v[96:99], v1, s[32:35], s64 offen offset:256 nt
    s_add_u32 s64, s64, 3072
    s_cmp_eq_u32 s64, s15
    s_cselect_b32 s64, s14, s64
    s_waitcnt vmcnt(3)
    buffer_load_dwordx4 v[100:103], v1, s[32:35], s64 offen offset:0 nt
    v_dot2c_f32_bf16 v29, v76, v8
    v_dot2c_f32_bf16 v29, v77, v9
    v_add_f32_dpp v28, v28, v28 quad_perm:[1,0,3,2] row_mask:0xf bank_mask:0xf
    v_dot2c_f32_bf16 v29, v78, v10
    v_dot2c_f32_bf16 v29, v79, v11
    v_add_f32_dpp v28, v28, v28 quad_perm:[2,3,0,1] row_mask:0xf bank_mask:0xf
    v_dot2c_f32_bf16 v29, v80, v12
    v_dot2c_f32_bf16 v29, v81, v13
    v_add_f32_dpp v28, v28, v28 row_half_mirror row_mask:0xf bank_mask:0xf
    v_dot2c_f32_bf16 v29, v82, v14
    v_dot2c_f32_bf16 v29, v83, v15
    v_cvt_pk_bf16_f32 v28, v28, v28
    v_dot2c_f32_bf16 v29, v84, v16
    v_and_b32 v28, 0xffff0000, v28
    v_dot2c_f32_bf16 v29, v85, v17
    v_mul_f32 v28, 0x3d93cd3a, v28
    v_dot2c_f32_bf16 v29, v86, v18
    v_cvt_pk_bf16_f32 v28, v28, v28
    v_dot2c_f32_bf16 v29, v87, v19
    v_and_b32 v28, 0xffff0000, v28
    s_add_u32 s31, s30, 0
    buffer_load_dwordx4 a[0:3], v7, s[44:47], s31 offen offset:0
    s_mul_i32 s75, s3, 384
    v_lshl_add_u32 v61, v0, 1, s75
    global_load_ushort v52, v61, s[16:17] offset:0
    global_load_ushort v55, v61, s[18:19] offset:0
    global_load_ushort v58, v61, s[20:21] offset:0
    global_load_ushort v53, v61, s[16:17] offset:128
    global_load_ushort v56, v61, s[18:19] offset:128
    global_load_ushort v59, v61, s[20:21] offset:128
    global_load_ushort v54, v61, s[16:17] offset:256
    global_load_ushort v57, v61, s[18:19] offset:256
    global_load_ushort v60, v61, s[20:21] offset:256
    v_mov_b32 v30, 0
    s_waitcnt vmcnt(13)
    s_waitcnt vmcnt(12)
    buffer_load_dwordx4 v[104:107], v1, s[32:35], s64 offen offset:128 nt
    s_waitcnt vmcnt(12)
    buffer_load_dwordx4 v[108:111], v1, s[32:35], s64 offen offset:256 nt
    s_add_u32 s64, s64, 3072
    s_cmp_eq_u32 s64, s15
    s_cselect_b32 s64, s14, s64
    v_dot2c_f32_bf16 v30, v88, v8
    v_dot2c_f32_bf16 v30, v89, v9
    v_add_f32_dpp v29, v29, v29 quad_perm:[1,0,3,2] row_mask:0xf bank_mask:0xf
    v_dot2c_f32_bf16 v30, v90, v10
    v_dot2c_f32_bf16 v30, v91, v11
    v_add_f32_dpp v29, v29, v29 quad_perm:[2,3,0,1] row_mask:0xf bank_mask:0xf
    v_dot2c_f32_bf16 v30, v92, v12
    v_dot2c_f32_bf16 v30, v93, v13
    v_add_f32_dpp v29, v29, v29 row_half_mirror row_mask:0xf bank_mask:0xf
    v_dot2c_f32_bf16 v30, v94, v14
    v_dot2c_f32_bf16 v30, v95, v15
    v_cvt_pk_bf16_f32 v29, v29, v29
    v_dot2c_f32_bf16 v30, v96, v16
    v_and_b32 v29, 0xffff0000, v29
    v_dot2c_f32_bf16 v30, v97, v17
    v_mul_f32 v29, 0x3d93cd3a, v29
    v_dot2c_f32_bf16 v30, v98, v18
    v_cvt_pk_bf16_f32 v29, v29, v29
    v_dot2c_f32_bf16 v30, v99, v19
    v_and_b32 v29, 0xffff0000, v29
    s_add_u32 s31, s30, 15360
    buffer_load_dwordx4 a[4:7], v7, s[44:47], s31 offen offset:0
    v_mov_b32 v31, 0
    s_waitcnt vmcnt(13)
    buffer_load_dwordx4 v[112:115], v1, s[32:35], s64 offen offset:0 nt
    s_waitcnt vmcnt(3)
    buffer_load_dwordx4 v[116:119], v1, s[32:35], s64 offen offset:128 nt
    s_waitcnt vmcnt(3)
    buffer_load_dwordx4 v[120:123], v1, s[32:35], s64 offen offset:256 nt
    s_add_u32 s64, s64, 3072
    s_cmp_eq_u32 s64, s15
    s_cselect_b32 s64, s14, s64
    v_dot2c_f32_bf16 v31, v100, v8
    v_dot2c_f32_bf16 v31, v101, v9
    v_add_f32_dpp v30, v30, v30 quad_perm:[1,0,3,2] row_mask:0xf bank_mask:0xf
    v_dot2c_f32_bf16 v31, v102, v10
    v_dot2c_f32_bf16 v31, v103, v11
    v_add_f32_dpp v30, v30, v30 quad_perm:[2,3,0,1] row_mask:0xf bank_mask:0xf
    v_dot2c_f32_bf16 v31, v104, v12
    v_dot2c_f32_bf16 v31, v105, v13
    v_add_f32_dpp v30, v30, v30 row_half_mirror row_mask:0xf bank_mask:0xf
    v_dot2c_f32_bf16 v31, v106, v14
    v_dot2c_f32_bf16 v31, v107, v15
    v_cvt_pk_bf16_f32 v30, v30, v30
    v_dot2c_f32_bf16 v31, v108, v16
    v_and_b32 v30, 0xffff0000, v30
    v_dot2c_f32_bf16 v31, v109, v17
    v_mul_f32 v30, 0x3d93cd3a, v30
    v_dot2c_f32_bf16 v31, v110, v18
    v_cvt_pk_bf16_f32 v30, v30, v30
    v_dot2c_f32_bf16 v31, v111, v19
    v_and_b32 v30, 0xffff0000, v30
    s_add_u32 s31, s30, 0
    buffer_load_dwordx4 a[8:11], v7, s[44:47], s31 offen offset:256
    v_mov_b32 v32, 0
    s_waitcnt vmcnt(3)
    buffer_load_dwordx4 v[124:127], v1, s[32:35], s64 offen offset:0 nt
    s_waitcnt vmcnt(3)
    buffer_load_dwordx4 v[128:131], v1, s[32:35], s64 offen offset:128 nt
    s_waitcnt vmcnt(3)
    buffer_load_dwordx4 v[132:135], v1, s[32:35], s64 offen offset:256 nt
    s_add_u32 s64, s64, 3072
    s_cmp_eq_u32 s64, s15
    s_cselect_b32 s64, s14, s64
    v_dot2c_f32_bf16 v32, v112, v8
    v_dot2c_f32_bf16 v32, v113, v9
    v_add_f32_dpp v31, v31, v31 quad_perm:[1,0,3,2] row_mask:0xf bank_mask:0xf
    v_dot2c_f32_bf16 v32, v114, v10
    v_dot2c_f32_bf16 v32, v115, v11
    v_add_f32_dpp v31, v31, v31 quad_perm:[2,3,0,1] row_mask:0xf bank_mask:0xf
    v_dot2c_f32_bf16 v32, v116, v12
    v_dot2c_f32_bf16 v32, v117, v13
    v_add_f32_dpp v31, v31, v31 row_half_mirror row_mask:0xf bank_mask:0xf
    v_dot2c_f32_bf16 v32, v118, v14
    v_dot2c_f32_bf16 v32, v119, v15
    v_cvt_pk_bf16_f32 v31, v31, v31
    v_dot2c_f32_bf16 v32, v120, v16
    v_and_b32 v31, 0xffff0000, v31
    v_dot2c_f32_bf16 v32, v121, v17
    v_mul_f32 v31, 0x3d93cd3a, v31
    v_dot2c_f32_bf16 v32, v122, v18
    v_cvt_pk_bf16_f32 v31, v31, v31
    v_dot2c_f32_bf16 v32, v123, v19
    v_and_b32 v31, 0xffff0000, v31
    v_mov_b32 v33, 0
    s_waitcnt vmcnt(2)
    buffer_load_dwordx4 v[76:79], v1, s[32:35], s64 offen offset:0 nt
    s_waitcnt vmcnt(2)
    buffer_load_dwordx4 v[80:83], v1, s[32:35], s64 offen offset:128 nt
    s_waitcnt vmcnt(2)
    buffer_load_dwordx4 v[84:87], v1, s[32:35], s64 offen offset:256 nt
    s_add_u32 s64, s64, 3072
    s_cmp_eq_u32 s64, s15
    s_cselect_b32 s64, s14, s64
    v_dot2c_f32_bf16 v33, v124, v8
    v_dot2c_f32_bf16 v33, v125, v9
    v_add_f32_dpp v32, v32, v32 quad_perm:[1,0,3,2] row_mask:0xf bank_mask:0xf
    v_dot2c_f32_bf16 v33, v126, v10
    v_dot2c_f32_bf16 v33, v127, v11
    v_add_f32_dpp v32, v32, v32 quad_perm:[2,3,0,1] row_mask:0xf bank_mask:0xf
    v_dot2c_f32_bf16 v33, v128, v12
    v_dot2c_f32_bf16 v33, v129, v13
    v_add_f32_dpp v32, v32, v32 row_half_mirror row_mask:0xf bank_mask:0xf
    v_dot2c_f32_bf16 v33, v130, v14
    v_dot2c_f32_bf16 v33, v131, v15
    v_cvt_pk_bf16_f32 v32, v32, v32
    v_dot2c_f32_bf16 v33, v132, v16
    v_and_b32 v32, 0xffff0000, v32
    v_dot2c_f32_bf16 v33, v133, v17
    v_mul_f32 v32, 0x3d93cd3a, v32
    v_dot2c_f32_bf16 v33, v134, v18
    v_cvt_pk_bf16_f32 v32, v32, v32
    v_dot2c_f32_bf16 v33, v135, v19
    v_and_b32 v32, 0xffff0000, v32
    s_add_u32 s31, s30, 15360
    buffer_load_dwordx4 a[12:15], v7, s[44:47], s31 offen offset:256
    v_mov_b32 v34, 0
    s_waitcnt vmcnt(3)
    buffer_load_dwordx4 v[88:91], v1, s[32:35], s64 offen offset:0 nt
    s_waitcnt vmcnt(3)
    buffer_load_dwordx4 v[92:95], v1, s[32:35], s64 offen offset:128 nt
    s_waitcnt vmcnt(3)
    buffer_load_dwordx4 v[96:99], v1, s[32:35], s64 offen offset:256 nt
    s_add_u32 s64, s64, 3072
    s_cmp_eq_u32 s64, s15
    s_cselect_b32 s64, s14, s64
    v_dot2c_f32_bf16 v34, v76, v8
    v_dot2c_f32_bf16 v34, v77, v9
    v_add_f32_dpp v33, v33, v33 quad_perm:[1,0,3,2] row_mask:0xf bank_mask:0xf
    v_dot2c_f32_bf16 v34, v78, v10
    v_dot2c_f32_bf16 v34, v79, v11
    v_add_f32_dpp v33, v33, v33 quad_perm:[2,3,0,1] row_mask:0xf bank_mask:0xf
    v_dot2c_f32_bf16 v34, v80, v12
    v_dot2c_f32_bf16 v34, v81, v13
    v_add_f32_dpp v33, v33, v33 row_half_mirror row_mask:0xf bank_mask:0xf
    v_dot2c_f32_bf16 v34, v82, v14
    v_dot2c_f32_bf16 v34, v83, v15
    v_cvt_pk_bf16_f32 v33, v33, v33
    v_dot2c_f32_bf16 v34, v84, v16
    v_and_b32 v33, 0xffff0000, v33
    v_dot2c_f32_bf16 v34, v85, v17
    v_mul_f32 v33, 0x3d93cd3a, v33
    v_dot2c_f32_bf16 v34, v86, v18
    v_cvt_pk_bf16_f32 v33, v33, v33
    v_dot2c_f32_bf16 v34, v87, v19
    v_and_b32 v33, 0xffff0000, v33
    s_add_u32 s31, s30, 0
    buffer_load_dwordx4 a[16:19], v7, s[44:47], s31 offen offset:512
    v_mov_b32 v35, 0
    s_waitcnt vmcnt(3)
    buffer_load_dwordx4 v[100:103], v1, s[32:35], s64 offen offset:0 nt
    s_waitcnt vmcnt(3)
    buffer_load_dwordx4 v[104:107], v1, s[32:35], s64 offen offset:128 nt
    s_waitcnt vmcnt(3)
    buffer_load_dwordx4 v[108:111], v1, s[32:35], s64 offen offset:256 nt
    s_add_u32 s64, s64, 3072
    s_cmp_eq_u32 s64, s15
    s_cselect_b32 s64, s14, s64
    v_dot2c_f32_bf16 v35, v88, v8
    v_dot2c_f32_bf16 v35, v89, v9
    v_add_f32_dpp v34, v34, v34 quad_perm:[1,0,3,2] row_mask:0xf bank_mask:0xf
    v_dot2c_f32_bf16 v35, v90, v10
    v_dot2c_f32_bf16 v35, v91, v11
    v_add_f32_dpp v34, v34, v34 quad_perm:[2,3,0,1] row_mask:0xf bank_mask:0xf
    v_dot2c_f32_bf16 v35, v92, v12
    v_dot2c_f32_bf16 v35, v93, v13
    v_add_f32_dpp v34, v34, v34 row_half_mirror row_mask:0xf bank_mask:0xf
    v_dot2c_f32_bf16 v35, v94, v14
    v_dot2c_f32_bf16 v35, v95, v15
    v_cvt_pk_bf16_f32 v34, v34, v34
    v_dot2c_f32_bf16 v35, v96, v16
    v_and_b32 v34, 0xffff0000, v34
    v_dot2c_f32_bf16 v35, v97, v17
    v_mul_f32 v34, 0x3d93cd3a, v34
    v_dot2c_f32_bf16 v35, v98, v18
    v_cvt_pk_bf16_f32 v34, v34, v34
    v_dot2c_f32_bf16 v35, v99, v19
    v_and_b32 v34, 0xffff0000, v34
    v_mov_b32 v36, 0
    s_waitcnt vmcnt(2)
    buffer_load_dwordx4 v[112:115], v1, s[32:35], s64 offen offset:0 nt
    s_waitcnt vmcnt(2)
    buffer_load_dwordx4 v[116:119], v1, s[32:35], s64 offen offset:128 nt
    s_waitcnt vmcnt(2)
    buffer_load_dwordx4 v[120:123], v1, s[32:35], s64 offen offset:256 nt
    s_add_u32 s64, s64, 3072
    s_cmp_eq_u32 s64, s15
    s_cselect_b32 s64, s14, s64
    v_dot2c_f32_bf16 v36, v100, v8
    v_dot2c_f32_bf16 v36, v101, v9
    v_add_f32_dpp v35, v35, v35 quad_perm:[1,0,3,2] row_mask:0xf bank_mask:0xf
    v_dot2c_f32_bf16 v36, v102, v10
    v_dot2c_f32_bf16 v36, v103, v11
    v_add_f32_dpp v35, v35, v35 quad_perm:[2,3,0,1] row_mask:0xf bank_mask:0xf
    v_dot2c_f32_bf16 v36, v104, v12
    v_dot2c_f32_bf16 v36, v105, v13
    v_add_f32_dpp v35, v35, v35 row_half_mirror row_mask:0xf bank_mask:0xf
    v_dot2c_f32_bf16 v36, v106, v14
    v_dot2c_f32_bf16 v36, v107, v15
    v_cvt_pk_bf16_f32 v35, v35, v35
    v_dot2c_f32_bf16 v36, v108, v16
    v_and_b32 v35, 0xffff0000, v35
    v_dot2c_f32_bf16 v36, v109, v17
    v_mul_f32 v35, 0x3d93cd3a, v35
    v_dot2c_f32_bf16 v36, v110, v18
    v_cvt_pk_bf16_f32 v35, v35, v35
    v_dot2c_f32_bf16 v36, v111, v19
    v_and_b32 v35, 0xffff0000, v35
    s_add_u32 s31, s30, 15360
    buffer_load_dwordx4 a[20:23], v7, s[44:47], s31 offen offset:512
    v_lshlrev_b32 v52, 16, v52
    v_lshlrev_b32 v53, 16, v53
    v_lshlrev_b32 v54, 16, v54
    v_lshlrev_b32 v55, 16, v55
    v_lshlrev_b32 v56, 16, v56
    v_lshlrev_b32 v57, 16, v57
    v_lshlrev_b32 v58, 16, v58
    v_lshlrev_b32 v59, 16, v59
    v_lshlrev_b32 v60, 16, v60
    v_mov_b32 v62, 0xc0135761
    v_mov_b32 v63, 0xbdd2d3e8
    v_bfe_u32 v49, v0, 4, 1
    v_lshrrev_b32 v61, 5, v0
    v_lshlrev_b32 v49, 3, v49
    v_lshl_add_u32 v49, v61, 2, v49
    s_lshl_b32 s66, s3, 7
    v_add_u32 v49, s66, v49
    s_and_b32 s100, s2, 127
    s_mul_i32 s100, s100, 24
    s_add_u32 s100, s100, 13824
    s_lshl_b32 s100, s100, 16
    s_lshr_b32 s66, s2, 7
    s_lshl_b32 s66, s66, 31
    s_or_b32 s100, s100, s66
    s_add_u32 s76, s100, 0
    s_add_u32 s77, s100, 65536
    s_add_u32 s78, s100, 131072
    s_add_u32 s79, s100, 196608
    v_pk_mul_f32 v[68:69], s[76:77], v[52:53] op_sel:[0,0] op_sel_hi:[1,0]
    v_pk_mul_f32 v[72:73], s[78:79], v[52:53] op_sel:[0,0] op_sel_hi:[1,0]
    v_cvt_pk_bf16_f32 v70, v68, v69
    v_cvt_pk_bf16_f32 v74, v72, v73
    v_lshlrev_b32 v68, 16, v70
    v_lshlrev_b32 v72, 16, v74
    v_and_b32 v69, 0xffff0000, v70
    v_and_b32 v73, 0xffff0000, v74
    v_pk_add_f32 v[68:69], v[68:69], v[54:55] op_sel:[0,1] op_sel_hi:[1,1]
    v_pk_add_f32 v[72:73], v[72:73], v[54:55] op_sel:[0,1] op_sel_hi:[1,1]
    v_cvt_pk_bf16_f32 v70, v68, v69
    v_cvt_pk_bf16_f32 v74, v72, v73
    v_lshlrev_b32 v68, 16, v70
    v_lshlrev_b32 v72, 16, v74
    v_and_b32 v69, 0xffff0000, v70
    v_and_b32 v73, 0xffff0000, v74
    v_pk_mul_f32 v[70:71], v[68:69], v[68:69]
    v_pk_mul_f32 v[74:75], v[72:73], v[72:73]
    v_pk_fma_f32 v[70:71], v[70:71], v[62:63], v[62:63] op_sel:[0,1,0] op_sel_hi:[1,1,0]
    v_pk_fma_f32 v[74:75], v[74:75], v[62:63], v[62:63] op_sel:[0,1,0] op_sel_hi:[1,1,0]
    v_pk_mul_f32 v[70:71], v[70:71], v[68:69]
    v_pk_mul_f32 v[74:75], v[74:75], v[72:73]
    v_exp_f32 v70, v70
    v_exp_f32 v74, v74
    v_exp_f32 v71, v71
    v_exp_f32 v75, v75
    v_pk_add_f32 v[70:71], v[70:71], 1.0 op_sel_hi:[1,0]
    v_pk_add_f32 v[74:75], v[74:75], 1.0 op_sel_hi:[1,0]
    v_rcp_f32 v70, v70
    v_rcp_f32 v74, v74
    v_rcp_f32 v71, v71
    v_rcp_f32 v75, v75
    v_pk_mul_f32 v[68:69], v[68:69], v[70:71]
    v_pk_mul_f32 v[72:73], v[72:73], v[74:75]
    v_cvt_pk_bf16_f32 v70, v68, v69
    v_cvt_pk_bf16_f32 v74, v72, v73
    v_lshlrev_b32 v68, 16, v70
    v_lshlrev_b32 v72, 16, v74
    v_and_b32 v69, 0xffff0000, v70
    v_and_b32 v73, 0xffff0000, v74
    v_pk_mul_f32 v[64:65], v[68:69], v[58:59] op_sel:[0,0] op_sel_hi:[1,0]
    v_pk_mul_f32 v[66:67], v[72:73], v[58:59] op_sel:[0,0] op_sel_hi:[1,0]
    v_pk_mul_f32 v[68:69], s[76:77], v[52:53] op_sel:[0,1] op_sel_hi:[1,1]
    v_pk_mul_f32 v[72:73], s[78:79], v[52:53] op_sel:[0,1] op_sel_hi:[1,1]
    v_cvt_pk_bf16_f32 v70, v68, v69
    v_cvt_pk_bf16_f32 v74, v72, v73
    v_lshlrev_b32 v68, 16, v70
    v_lshlrev_b32 v72, 16, v74
    v_and_b32 v69, 0xffff0000, v70
    v_and_b32 v73, 0xffff0000, v74
    v_pk_add_f32 v[68:69], v[68:69], v[56:57] op_sel:[0,0] op_sel_hi:[1,0]
    v_pk_add_f32 v[72:73], v[72:73], v[56:57] op_sel:[0,0] op_sel_hi:[1,0]
    v_cvt_pk_bf16_f32 v70, v68, v69
    v_cvt_pk_bf16_f32 v74, v72, v73
    v_lshlrev_b32 v68, 16, v70
    v_lshlrev_b32 v72, 16, v74
    v_and_b32 v69, 0xffff0000, v70
    v_and_b32 v73, 0xffff0000, v74
    v_pk_mul_f32 v[70:71], v[68:69], v[68:69]
    v_pk_mul_f32 v[74:75], v[72:73], v[72:73]
    v_pk_fma_f32 v[70:71], v[70:71], v[62:63], v[62:63] op_sel:[0,1,0] op_sel_hi:[1,1,0]
    v_pk_fma_f32 v[74:75], v[74:75], v[62:63], v[62:63] op_sel:[0,1,0] op_sel_hi:[1,1,0]
    v_pk_mul_f32 v[70:71], v[70:71], v[68:69]
    v_pk_mul_f32 v[74:75], v[74:75], v[72:73]
    v_exp_f32 v70, v70
    v_exp_f32 v74, v74
    v_exp_f32 v71, v71
    v_exp_f32 v75, v75
    v_pk_add_f32 v[70:71], v[70:71], 1.0 op_sel_hi:[1,0]
    v_pk_add_f32 v[74:75], v[74:75], 1.0 op_sel_hi:[1,0]
    v_rcp_f32 v70, v70
    v_rcp_f32 v74, v74
    v_rcp_f32 v71, v71
    v_rcp_f32 v75, v75
    v_pk_mul_f32 v[68:69], v[68:69], v[70:71]
    v_pk_mul_f32 v[72:73], v[72:73], v[74:75]
    v_cvt_pk_bf16_f32 v70, v68, v69
    v_cvt_pk_bf16_f32 v74, v72, v73
    v_lshlrev_b32 v68, 16, v70
    v_lshlrev_b32 v72, 16, v74
    v_and_b32 v69, 0xffff0000, v70
    v_and_b32 v73, 0xffff0000, v74
    v_pk_fma_f32 v[64:65], v[68:69], v[58:59], v[64:65] op_sel:[0,1,0] op_sel_hi:[1,1,1]
    v_pk_fma_f32 v[66:67], v[72:73], v[58:59], v[66:67] op_sel:[0,1,0] op_sel_hi:[1,1,1]
    v_mov_b32 v37, 0
    s_waitcnt vmcnt(3)
    buffer_load_dwordx4 v[124:127], v1, s[32:35], s64 offen offset:0 nt
    s_waitcnt vmcnt(3)
    buffer_load_dwordx4 v[128:131], v1, s[32:35], s64 offen offset:128 nt
    s_waitcnt vmcnt(3)
    buffer_load_dwordx4 v[132:135], v1, s[32:35], s64 offen offset:256 nt
    s_add_u32 s64, s64, 3072
    s_cmp_eq_u32 s64, s15
    s_cselect_b32 s64, s14, s64
    v_dot2c_f32_bf16 v37, v112, v8
    v_dot2c_f32_bf16 v37, v113, v9
    v_add_f32_dpp v36, v36, v36 quad_perm:[1,0,3,2] row_mask:0xf bank_mask:0xf
    v_dot2c_f32_bf16 v37, v114, v10
    v_dot2c_f32_bf16 v37, v115, v11
    v_add_f32_dpp v36, v36, v36 quad_perm:[2,3,0,1] row_mask:0xf bank_mask:0xf
    v_dot2c_f32_bf16 v37, v116, v12
    v_dot2c_f32_bf16 v37, v117, v13
    v_add_f32_dpp v36, v36, v36 row_half_mirror row_mask:0xf bank_mask:0xf
    v_dot2c_f32_bf16 v37, v118, v14
    v_dot2c_f32_bf16 v37, v119, v15
    v_cvt_pk_bf16_f32 v36, v36, v36
    v_dot2c_f32_bf16 v37, v120, v16
    v_and_b32 v36, 0xffff0000, v36
    v_dot2c_f32_bf16 v37, v121, v17
    v_mul_f32 v36, 0x3d93cd3a, v36
    v_dot2c_f32_bf16 v37, v122, v18
    v_cvt_pk_bf16_f32 v36, v36, v36
    v_dot2c_f32_bf16 v37, v123, v19
    v_and_b32 v36, 0xffff0000, v36
    s_add_u32 s31, s30, 0
    buffer_load_dwordx4 a[24:27], v7, s[44:47], s31 offen offset:768
    v_pk_mul_f32 v[68:69], s[76:77], v[54:55] op_sel:[0,0] op_sel_hi:[1,0]
    v_pk_mul_f32 v[72:73], s[78:79], v[54:55] op_sel:[0,0] op_sel_hi:[1,0]
    v_cvt_pk_bf16_f32 v70, v68, v69
    v_cvt_pk_bf16_f32 v74, v72, v73
    v_lshlrev_b32 v68, 16, v70
    v_lshlrev_b32 v72, 16, v74
    v_and_b32 v69, 0xffff0000, v70
    v_and_b32 v73, 0xffff0000, v74
    v_pk_add_f32 v[68:69], v[68:69], v[56:57] op_sel:[0,1] op_sel_hi:[1,1]
    v_pk_add_f32 v[72:73], v[72:73], v[56:57] op_sel:[0,1] op_sel_hi:[1,1]
    v_cvt_pk_bf16_f32 v70, v68, v69
    v_cvt_pk_bf16_f32 v74, v72, v73
    v_lshlrev_b32 v68, 16, v70
    v_lshlrev_b32 v72, 16, v74
    v_and_b32 v69, 0xffff0000, v70
    v_and_b32 v73, 0xffff0000, v74
    v_pk_mul_f32 v[70:71], v[68:69], v[68:69]
    v_pk_mul_f32 v[74:75], v[72:73], v[72:73]
    v_pk_fma_f32 v[70:71], v[70:71], v[62:63], v[62:63] op_sel:[0,1,0] op_sel_hi:[1,1,0]
    v_pk_fma_f32 v[74:75], v[74:75], v[62:63], v[62:63] op_sel:[0,1,0] op_sel_hi:[1,1,0]
    v_pk_mul_f32 v[70:71], v[70:71], v[68:69]
    v_pk_mul_f32 v[74:75], v[74:75], v[72:73]
    v_exp_f32 v70, v70
    v_exp_f32 v74, v74
    v_exp_f32 v71, v71
    v_exp_f32 v75, v75
    v_pk_add_f32 v[70:71], v[70:71], 1.0 op_sel_hi:[1,0]
    v_pk_add_f32 v[74:75], v[74:75], 1.0 op_sel_hi:[1,0]
    v_rcp_f32 v70, v70
    v_rcp_f32 v74, v74
    v_rcp_f32 v71, v71
    v_rcp_f32 v75, v75
    v_pk_mul_f32 v[68:69], v[68:69], v[70:71]
    v_pk_mul_f32 v[72:73], v[72:73], v[74:75]
    v_cvt_pk_bf16_f32 v70, v68, v69
    v_cvt_pk_bf16_f32 v74, v72, v73
    v_lshlrev_b32 v68, 16, v70
    v_lshlrev_b32 v72, 16, v74
    v_and_b32 v69, 0xffff0000, v70
    v_and_b32 v73, 0xffff0000, v74
    v_pk_fma_f32 v[64:65], v[68:69], v[60:61], v[64:65] op_sel:[0,0,0] op_sel_hi:[1,0,1]
    v_pk_fma_f32 v[66:67], v[72:73], v[60:61], v[66:67] op_sel:[0,0,0] op_sel_hi:[1,0,1]
    s_nop 1
    v_permlane32_swap_b32 v64, v65
    v_permlane32_swap_b32 v66, v67
    v_add_f32 v64, v64, v65
    v_add_f32 v66, v66, v67
    s_nop 1
    v_permlane16_swap_b32 v64, v66
    v_add_f32 v64, v64, v66
    s_nop 1
    v_add_f32_dpp v64, v64, v64 quad_perm:[1,0,3,2] row_mask:0xf bank_mask:0xf
    s_nop 1
    v_add_f32_dpp v64, v64, v64 quad_perm:[2,3,0,1] row_mask:0xf bank_mask:0xf
    s_nop 1
    v_add_f32_dpp v64, v64, v64 row_half_mirror row_mask:0xf bank_mask:0xf
    s_nop 1
    v_add_f32_dpp v64, v64, v64 row_mirror row_mask:0xf bank_mask:0xf
    s_mov_b32 exec_lo, 0x00010001
    s_mov_b32 exec_hi, 0x00010001
    ds_write_b32 v49, v64 offset:13312
    s_mov_b64 exec, -1
    v_mov_b32 v38, 0
    s_waitcnt vmcnt(3)
    buffer_load_dwordx4 v[76:79], v1, s[32:35], s64 offen offset:0 nt
    s_waitcnt vmcnt(3)
    buffer_load_dwordx4 v[80:83], v1, s[32:35], s64 offen offset:128 nt
    s_waitcnt vmcnt(3)
    buffer_load_dwordx4 v[84:87], v1, s[32:35], s64 offen offset:256 nt
    s_add_u32 s64, s64, 3072
    s_cmp_eq_u32 s64, s15
    s_cselect_b32 s64, s14, s64
    v_dot2c_f32_bf16 v38, v124, v8
    v_dot2c_f32_bf16 v38, v125, v9
    v_add_f32_dpp v37, v37, v37 quad_perm:[1,0,3,2] row_mask:0xf bank_mask:0xf
    v_dot2c_f32_bf16 v38, v126, v10
    v_dot2c_f32_bf16 v38, v127, v11
    v_add_f32_dpp v37, v37, v37 quad_perm:[2,3,0,1] row_mask:0xf bank_mask:0xf
    v_dot2c_f32_bf16 v38, v128, v12
    v_dot2c_f32_bf16 v38, v129, v13
    v_add_f32_dpp v37, v37, v37 row_half_mirror row_mask:0xf bank_mask:0xf
    v_dot2c_f32_bf16 v38, v130, v14
    v_dot2c_f32_bf16 v38, v131, v15
    v_cvt_pk_bf16_f32 v37, v37, v37
    v_dot2c_f32_bf16 v38, v132, v16
    v_and_b32 v37, 0xffff0000, v37
    v_dot2c_f32_bf16 v38, v133, v17
    v_mul_f32 v37, 0x3d93cd3a, v37
    v_dot2c_f32_bf16 v38, v134, v18
    v_cvt_pk_bf16_f32 v37, v37, v37
    v_dot2c_f32_bf16 v38, v135, v19
    v_and_b32 v37, 0xffff0000, v37
    s_add_u32 s31, s30, 15360
    buffer_load_dwordx4 a[28:31], v7, s[44:47], s31 offen offset:768
    s_add_u32 s76, s100, 262144
    s_add_u32 s77, s100, 327680
    s_add_u32 s78, s100, 393216
    s_add_u32 s79, s100, 458752
    v_pk_mul_f32 v[68:69], s[76:77], v[52:53] op_sel:[0,0] op_sel_hi:[1,0]
    v_pk_mul_f32 v[72:73], s[78:79], v[52:53] op_sel:[0,0] op_sel_hi:[1,0]
    v_cvt_pk_bf16_f32 v70, v68, v69
    v_cvt_pk_bf16_f32 v74, v72, v73
    v_lshlrev_b32 v68, 16, v70
    v_lshlrev_b32 v72, 16, v74
    v_and_b32 v69, 0xffff0000, v70
    v_and_b32 v73, 0xffff0000, v74
    v_pk_add_f32 v[68:69], v[68:69], v[54:55] op_sel:[0,1] op_sel_hi:[1,1]
    v_pk_add_f32 v[72:73], v[72:73], v[54:55] op_sel:[0,1] op_sel_hi:[1,1]
    v_cvt_pk_bf16_f32 v70, v68, v69
    v_cvt_pk_bf16_f32 v74, v72, v73
    v_lshlrev_b32 v68, 16, v70
    v_lshlrev_b32 v72, 16, v74
    v_and_b32 v69, 0xffff0000, v70
    v_and_b32 v73, 0xffff0000, v74
    v_pk_mul_f32 v[70:71], v[68:69], v[68:69]
    v_pk_mul_f32 v[74:75], v[72:73], v[72:73]
    v_pk_fma_f32 v[70:71], v[70:71], v[62:63], v[62:63] op_sel:[0,1,0] op_sel_hi:[1,1,0]
    v_pk_fma_f32 v[74:75], v[74:75], v[62:63], v[62:63] op_sel:[0,1,0] op_sel_hi:[1,1,0]
    v_pk_mul_f32 v[70:71], v[70:71], v[68:69]
    v_pk_mul_f32 v[74:75], v[74:75], v[72:73]
    v_exp_f32 v70, v70
    v_exp_f32 v74, v74
    v_exp_f32 v71, v71
    v_exp_f32 v75, v75
    v_pk_add_f32 v[70:71], v[70:71], 1.0 op_sel_hi:[1,0]
    v_pk_add_f32 v[74:75], v[74:75], 1.0 op_sel_hi:[1,0]
    v_rcp_f32 v70, v70
    v_rcp_f32 v74, v74
    v_rcp_f32 v71, v71
    v_rcp_f32 v75, v75
    v_pk_mul_f32 v[68:69], v[68:69], v[70:71]
    v_pk_mul_f32 v[72:73], v[72:73], v[74:75]
    v_cvt_pk_bf16_f32 v70, v68, v69
    v_cvt_pk_bf16_f32 v74, v72, v73
    v_lshlrev_b32 v68, 16, v70
    v_lshlrev_b32 v72, 16, v74
    v_and_b32 v69, 0xffff0000, v70
    v_and_b32 v73, 0xffff0000, v74
    v_pk_mul_f32 v[64:65], v[68:69], v[58:59] op_sel:[0,0] op_sel_hi:[1,0]
    v_pk_mul_f32 v[66:67], v[72:73], v[58:59] op_sel:[0,0] op_sel_hi:[1,0]
    v_pk_mul_f32 v[68:69], s[76:77], v[52:53] op_sel:[0,1] op_sel_hi:[1,1]
    v_pk_mul_f32 v[72:73], s[78:79], v[52:53] op_sel:[0,1] op_sel_hi:[1,1]
    v_cvt_pk_bf16_f32 v70, v68, v69
    v_cvt_pk_bf16_f32 v74, v72, v73
    v_lshlrev_b32 v68, 16, v70
    v_lshlrev_b32 v72, 16, v74
    v_and_b32 v69, 0xffff0000, v70
    v_and_b32 v73, 0xffff0000, v74
    v_pk_add_f32 v[68:69], v[68:69], v[56:57] op_sel:[0,0] op_sel_hi:[1,0]
    v_pk_add_f32 v[72:73], v[72:73], v[56:57] op_sel:[0,0] op_sel_hi:[1,0]
    v_cvt_pk_bf16_f32 v70, v68, v69
    v_cvt_pk_bf16_f32 v74, v72, v73
    v_lshlrev_b32 v68, 16, v70
    v_lshlrev_b32 v72, 16, v74
    v_and_b32 v69, 0xffff0000, v70
    v_and_b32 v73, 0xffff0000, v74
    v_pk_mul_f32 v[70:71], v[68:69], v[68:69]
    v_pk_mul_f32 v[74:75], v[72:73], v[72:73]
    v_pk_fma_f32 v[70:71], v[70:71], v[62:63], v[62:63] op_sel:[0,1,0] op_sel_hi:[1,1,0]
    v_pk_fma_f32 v[74:75], v[74:75], v[62:63], v[62:63] op_sel:[0,1,0] op_sel_hi:[1,1,0]
    v_pk_mul_f32 v[70:71], v[70:71], v[68:69]
    v_pk_mul_f32 v[74:75], v[74:75], v[72:73]
    v_exp_f32 v70, v70
    v_exp_f32 v74, v74
    v_exp_f32 v71, v71
    v_exp_f32 v75, v75
    v_pk_add_f32 v[70:71], v[70:71], 1.0 op_sel_hi:[1,0]
    v_pk_add_f32 v[74:75], v[74:75], 1.0 op_sel_hi:[1,0]
    v_rcp_f32 v70, v70
    v_rcp_f32 v74, v74
    v_rcp_f32 v71, v71
    v_rcp_f32 v75, v75
    v_pk_mul_f32 v[68:69], v[68:69], v[70:71]
    v_pk_mul_f32 v[72:73], v[72:73], v[74:75]
    v_cvt_pk_bf16_f32 v70, v68, v69
    v_cvt_pk_bf16_f32 v74, v72, v73
    v_lshlrev_b32 v68, 16, v70
    v_lshlrev_b32 v72, 16, v74
    v_and_b32 v69, 0xffff0000, v70
    v_and_b32 v73, 0xffff0000, v74
    v_pk_fma_f32 v[64:65], v[68:69], v[58:59], v[64:65] op_sel:[0,1,0] op_sel_hi:[1,1,1]
    v_pk_fma_f32 v[66:67], v[72:73], v[58:59], v[66:67] op_sel:[0,1,0] op_sel_hi:[1,1,1]
    v_mov_b32 v39, 0
    s_waitcnt vmcnt(3)
    buffer_load_dwordx4 v[88:91], v1, s[32:35], s64 offen offset:0 nt
    s_waitcnt vmcnt(3)
    buffer_load_dwordx4 v[92:95], v1, s[32:35], s64 offen offset:128 nt
    s_waitcnt vmcnt(3)
    buffer_load_dwordx4 v[96:99], v1, s[32:35], s64 offen offset:256 nt
    s_add_u32 s64, s64, 3072
    s_cmp_eq_u32 s64, s15
    s_cselect_b32 s64, s14, s64
    v_dot2c_f32_bf16 v39, v76, v8
    v_dot2c_f32_bf16 v39, v77, v9
    v_add_f32_dpp v38, v38, v38 quad_perm:[1,0,3,2] row_mask:0xf bank_mask:0xf
    v_dot2c_f32_bf16 v39, v78, v10
    v_dot2c_f32_bf16 v39, v79, v11
    v_add_f32_dpp v38, v38, v38 quad_perm:[2,3,0,1] row_mask:0xf bank_mask:0xf
    v_dot2c_f32_bf16 v39, v80, v12
    v_dot2c_f32_bf16 v39, v81, v13
    v_add_f32_dpp v38, v38, v38 row_half_mirror row_mask:0xf bank_mask:0xf
    v_dot2c_f32_bf16 v39, v82, v14
    v_dot2c_f32_bf16 v39, v83, v15
    v_cvt_pk_bf16_f32 v38, v38, v38
    v_dot2c_f32_bf16 v39, v84, v16
    v_and_b32 v38, 0xffff0000, v38
    v_dot2c_f32_bf16 v39, v85, v17
    v_mul_f32 v38, 0x3d93cd3a, v38
    v_dot2c_f32_bf16 v39, v86, v18
    v_cvt_pk_bf16_f32 v38, v38, v38
    v_dot2c_f32_bf16 v39, v87, v19
    v_and_b32 v38, 0xffff0000, v38
    v_pk_mul_f32 v[68:69], s[76:77], v[54:55] op_sel:[0,0] op_sel_hi:[1,0]
    v_pk_mul_f32 v[72:73], s[78:79], v[54:55] op_sel:[0,0] op_sel_hi:[1,0]
    v_cvt_pk_bf16_f32 v70, v68, v69
    v_cvt_pk_bf16_f32 v74, v72, v73
    v_lshlrev_b32 v68, 16, v70
    v_lshlrev_b32 v72, 16, v74
    v_and_b32 v69, 0xffff0000, v70
    v_and_b32 v73, 0xffff0000, v74
    v_pk_add_f32 v[68:69], v[68:69], v[56:57] op_sel:[0,1] op_sel_hi:[1,1]
    v_pk_add_f32 v[72:73], v[72:73], v[56:57] op_sel:[0,1] op_sel_hi:[1,1]
    v_cvt_pk_bf16_f32 v70, v68, v69
    v_cvt_pk_bf16_f32 v74, v72, v73
    v_lshlrev_b32 v68, 16, v70
    v_lshlrev_b32 v72, 16, v74
    v_and_b32 v69, 0xffff0000, v70
    v_and_b32 v73, 0xffff0000, v74
    v_pk_mul_f32 v[70:71], v[68:69], v[68:69]
    v_pk_mul_f32 v[74:75], v[72:73], v[72:73]
    v_pk_fma_f32 v[70:71], v[70:71], v[62:63], v[62:63] op_sel:[0,1,0] op_sel_hi:[1,1,0]
    v_pk_fma_f32 v[74:75], v[74:75], v[62:63], v[62:63] op_sel:[0,1,0] op_sel_hi:[1,1,0]
    v_pk_mul_f32 v[70:71], v[70:71], v[68:69]
    v_pk_mul_f32 v[74:75], v[74:75], v[72:73]
    v_exp_f32 v70, v70
    v_exp_f32 v74, v74
    v_exp_f32 v71, v71
    v_exp_f32 v75, v75
    v_pk_add_f32 v[70:71], v[70:71], 1.0 op_sel_hi:[1,0]
    v_pk_add_f32 v[74:75], v[74:75], 1.0 op_sel_hi:[1,0]
    v_rcp_f32 v70, v70
    v_rcp_f32 v74, v74
    v_rcp_f32 v71, v71
    v_rcp_f32 v75, v75
    v_pk_mul_f32 v[68:69], v[68:69], v[70:71]
    v_pk_mul_f32 v[72:73], v[72:73], v[74:75]
    v_cvt_pk_bf16_f32 v70, v68, v69
    v_cvt_pk_bf16_f32 v74, v72, v73
    v_lshlrev_b32 v68, 16, v70
    v_lshlrev_b32 v72, 16, v74
    v_and_b32 v69, 0xffff0000, v70
    v_and_b32 v73, 0xffff0000, v74
    v_pk_fma_f32 v[64:65], v[68:69], v[60:61], v[64:65] op_sel:[0,0,0] op_sel_hi:[1,0,1]
    v_pk_fma_f32 v[66:67], v[72:73], v[60:61], v[66:67] op_sel:[0,0,0] op_sel_hi:[1,0,1]
    s_nop 1
    v_permlane32_swap_b32 v64, v65
    v_permlane32_swap_b32 v66, v67
    v_add_f32 v64, v64, v65
    v_add_f32 v66, v66, v67
    s_nop 1
    v_permlane16_swap_b32 v64, v66
    v_add_f32 v64, v64, v66
    s_nop 1
    v_add_f32_dpp v64, v64, v64 quad_perm:[1,0,3,2] row_mask:0xf bank_mask:0xf
    s_nop 1
    v_add_f32_dpp v64, v64, v64 quad_perm:[2,3,0,1] row_mask:0xf bank_mask:0xf
    s_nop 1
    v_add_f32_dpp v64, v64, v64 row_half_mirror row_mask:0xf bank_mask:0xf
    s_nop 1
    v_add_f32_dpp v64, v64, v64 row_mirror row_mask:0xf bank_mask:0xf
    s_mov_b32 exec_lo, 0x00010001
    s_mov_b32 exec_hi, 0x00010001
    ds_write_b32 v49, v64 offset:13328
    s_mov_b64 exec, -1
    v_mov_b32 v40, 0
    s_waitcnt vmcnt(2)
    buffer_load_dwordx4 v[100:103], v1, s[32:35], s64 offen offset:0 nt
    s_waitcnt vmcnt(2)
    buffer_load_dwordx4 v[104:107], v1, s[32:35], s64 offen offset:128 nt
    s_waitcnt vmcnt(2)
    buffer_load_dwordx4 v[108:111], v1, s[32:35], s64 offen offset:256 nt
    s_add_u32 s64, s64, 3072
    s_cmp_eq_u32 s64, s15
    s_cselect_b32 s64, s14, s64
    v_dot2c_f32_bf16 v40, v88, v8
    v_dot2c_f32_bf16 v40, v89, v9
    v_add_f32_dpp v39, v39, v39 quad_perm:[1,0,3,2] row_mask:0xf bank_mask:0xf
    v_dot2c_f32_bf16 v40, v90, v10
    v_dot2c_f32_bf16 v40, v91, v11
    v_add_f32_dpp v39, v39, v39 quad_perm:[2,3,0,1] row_mask:0xf bank_mask:0xf
    v_dot2c_f32_bf16 v40, v92, v12
    v_dot2c_f32_bf16 v40, v93, v13
    v_add_f32_dpp v39, v39, v39 row_half_mirror row_mask:0xf bank_mask:0xf
    v_dot2c_f32_bf16 v40, v94, v14
    v_dot2c_f32_bf16 v40, v95, v15
    v_cvt_pk_bf16_f32 v39, v39, v39
    v_dot2c_f32_bf16 v40, v96, v16
    v_and_b32 v39, 0xffff0000, v39
    v_dot2c_f32_bf16 v40, v97, v17
    v_mul_f32 v39, 0x3d93cd3a, v39
    v_dot2c_f32_bf16 v40, v98, v18
    v_cvt_pk_bf16_f32 v39, v39, v39
    v_dot2c_f32_bf16 v40, v99, v19
    v_and_b32 v39, 0xffff0000, v39
    s_add_u32 s31, s30, 0
    buffer_load_dwordx4 a[32:35], v7, s[44:47], s31 offen offset:1024
    s_add_u32 s76, s100, 524288
    s_add_u32 s77, s100, 589824
    s_add_u32 s78, s100, 655360
    s_add_u32 s79, s100, 720896
    v_pk_mul_f32 v[68:69], s[76:77], v[52:53] op_sel:[0,0] op_sel_hi:[1,0]
    v_pk_mul_f32 v[72:73], s[78:79], v[52:53] op_sel:[0,0] op_sel_hi:[1,0]
    v_cvt_pk_bf16_f32 v70, v68, v69
    v_cvt_pk_bf16_f32 v74, v72, v73
    v_lshlrev_b32 v68, 16, v70
    v_lshlrev_b32 v72, 16, v74
    v_and_b32 v69, 0xffff0000, v70
    v_and_b32 v73, 0xffff0000, v74
    v_pk_add_f32 v[68:69], v[68:69], v[54:55] op_sel:[0,1] op_sel_hi:[1,1]
    v_pk_add_f32 v[72:73], v[72:73], v[54:55] op_sel:[0,1] op_sel_hi:[1,1]
    v_cvt_pk_bf16_f32 v70, v68, v69
    v_cvt_pk_bf16_f32 v74, v72, v73
    v_lshlrev_b32 v68, 16, v70
    v_lshlrev_b32 v72, 16, v74
    v_and_b32 v69, 0xffff0000, v70
    v_and_b32 v73, 0xffff0000, v74
    v_pk_mul_f32 v[70:71], v[68:69], v[68:69]
    v_pk_mul_f32 v[74:75], v[72:73], v[72:73]
    v_pk_fma_f32 v[70:71], v[70:71], v[62:63], v[62:63] op_sel:[0,1,0] op_sel_hi:[1,1,0]
    v_pk_fma_f32 v[74:75], v[74:75], v[62:63], v[62:63] op_sel:[0,1,0] op_sel_hi:[1,1,0]
    v_pk_mul_f32 v[70:71], v[70:71], v[68:69]
    v_pk_mul_f32 v[74:75], v[74:75], v[72:73]
    v_exp_f32 v70, v70
    v_exp_f32 v74, v74
    v_exp_f32 v71, v71
    v_exp_f32 v75, v75
    v_pk_add_f32 v[70:71], v[70:71], 1.0 op_sel_hi:[1,0]
    v_pk_add_f32 v[74:75], v[74:75], 1.0 op_sel_hi:[1,0]
    v_rcp_f32 v70, v70
    v_rcp_f32 v74, v74
    v_rcp_f32 v71, v71
    v_rcp_f32 v75, v75
    v_pk_mul_f32 v[68:69], v[68:69], v[70:71]
    v_pk_mul_f32 v[72:73], v[72:73], v[74:75]
    v_cvt_pk_bf16_f32 v70, v68, v69
    v_cvt_pk_bf16_f32 v74, v72, v73
    v_lshlrev_b32 v68, 16, v70
    v_lshlrev_b32 v72, 16, v74
    v_and_b32 v69, 0xffff0000, v70
    v_and_b32 v73, 0xffff0000, v74
    v_pk_mul_f32 v[64:65], v[68:69], v[58:59] op_sel:[0,0] op_sel_hi:[1,0]
    v_pk_mul_f32 v[66:67], v[72:73], v[58:59] op_sel:[0,0] op_sel_hi:[1,0]
    v_pk_mul_f32 v[68:69], s[76:77], v[52:53] op_sel:[0,1] op_sel_hi:[1,1]
    v_pk_mul_f32 v[72:73], s[78:79], v[52:53] op_sel:[0,1] op_sel_hi:[1,1]
    v_cvt_pk_bf16_f32 v70, v68, v69
    v_cvt_pk_bf16_f32 v74, v72, v73
    v_lshlrev_b32 v68, 16, v70
    v_lshlrev_b32 v72, 16, v74
    v_and_b32 v69, 0xffff0000, v70
    v_and_b32 v73, 0xffff0000, v74
    v_pk_add_f32 v[68:69], v[68:69], v[56:57] op_sel:[0,0] op_sel_hi:[1,0]
    v_pk_add_f32 v[72:73], v[72:73], v[56:57] op_sel:[0,0] op_sel_hi:[1,0]
    v_cvt_pk_bf16_f32 v70, v68, v69
    v_cvt_pk_bf16_f32 v74, v72, v73
    v_lshlrev_b32 v68, 16, v70
    v_lshlrev_b32 v72, 16, v74
    v_and_b32 v69, 0xffff0000, v70
    v_and_b32 v73, 0xffff0000, v74
    v_pk_mul_f32 v[70:71], v[68:69], v[68:69]
    v_pk_mul_f32 v[74:75], v[72:73], v[72:73]
    v_pk_fma_f32 v[70:71], v[70:71], v[62:63], v[62:63] op_sel:[0,1,0] op_sel_hi:[1,1,0]
    v_pk_fma_f32 v[74:75], v[74:75], v[62:63], v[62:63] op_sel:[0,1,0] op_sel_hi:[1,1,0]
    v_pk_mul_f32 v[70:71], v[70:71], v[68:69]
    v_pk_mul_f32 v[74:75], v[74:75], v[72:73]
    v_exp_f32 v70, v70
    v_exp_f32 v74, v74
    v_exp_f32 v71, v71
    v_exp_f32 v75, v75
    v_pk_add_f32 v[70:71], v[70:71], 1.0 op_sel_hi:[1,0]
    v_pk_add_f32 v[74:75], v[74:75], 1.0 op_sel_hi:[1,0]
    v_rcp_f32 v70, v70
    v_rcp_f32 v74, v74
    v_rcp_f32 v71, v71
    v_rcp_f32 v75, v75
    v_pk_mul_f32 v[68:69], v[68:69], v[70:71]
    v_pk_mul_f32 v[72:73], v[72:73], v[74:75]
    v_cvt_pk_bf16_f32 v70, v68, v69
    v_cvt_pk_bf16_f32 v74, v72, v73
    v_lshlrev_b32 v68, 16, v70
    v_lshlrev_b32 v72, 16, v74
    v_and_b32 v69, 0xffff0000, v70
    v_and_b32 v73, 0xffff0000, v74
    v_pk_fma_f32 v[64:65], v[68:69], v[58:59], v[64:65] op_sel:[0,1,0] op_sel_hi:[1,1,1]
    v_pk_fma_f32 v[66:67], v[72:73], v[58:59], v[66:67] op_sel:[0,1,0] op_sel_hi:[1,1,1]
    v_mov_b32 v41, 0
    s_waitcnt vmcnt(3)
    buffer_load_dwordx4 v[112:115], v1, s[32:35], s64 offen offset:0 nt
    s_waitcnt vmcnt(3)
    buffer_load_dwordx4 v[116:119], v1, s[32:35], s64 offen offset:128 nt
    s_waitcnt vmcnt(3)
    buffer_load_dwordx4 v[120:123], v1, s[32:35], s64 offen offset:256 nt
    s_add_u32 s64, s64, 3072
    s_cmp_eq_u32 s64, s15
    s_cselect_b32 s64, s14, s64
    v_dot2c_f32_bf16 v41, v100, v8
    v_dot2c_f32_bf16 v41, v101, v9
    v_add_f32_dpp v40, v40, v40 quad_perm:[1,0,3,2] row_mask:0xf bank_mask:0xf
    v_dot2c_f32_bf16 v41, v102, v10
    v_dot2c_f32_bf16 v41, v103, v11
    v_add_f32_dpp v40, v40, v40 quad_perm:[2,3,0,1] row_mask:0xf bank_mask:0xf
    v_dot2c_f32_bf16 v41, v104, v12
    v_dot2c_f32_bf16 v41, v105, v13
    v_add_f32_dpp v40, v40, v40 row_half_mirror row_mask:0xf bank_mask:0xf
    v_dot2c_f32_bf16 v41, v106, v14
    v_dot2c_f32_bf16 v41, v107, v15
    v_cvt_pk_bf16_f32 v40, v40, v40
    v_dot2c_f32_bf16 v41, v108, v16
    v_and_b32 v40, 0xffff0000, v40
    v_dot2c_f32_bf16 v41, v109, v17
    v_mul_f32 v40, 0x3d93cd3a, v40
    v_dot2c_f32_bf16 v41, v110, v18
    v_cvt_pk_bf16_f32 v40, v40, v40
    v_dot2c_f32_bf16 v41, v111, v19
    v_and_b32 v40, 0xffff0000, v40
    s_add_u32 s31, s30, 15360
    buffer_load_dwordx4 a[36:39], v7, s[44:47], s31 offen offset:1024
    v_pk_mul_f32 v[68:69], s[76:77], v[54:55] op_sel:[0,0] op_sel_hi:[1,0]
    v_pk_mul_f32 v[72:73], s[78:79], v[54:55] op_sel:[0,0] op_sel_hi:[1,0]
    v_cvt_pk_bf16_f32 v70, v68, v69
    v_cvt_pk_bf16_f32 v74, v72, v73
    v_lshlrev_b32 v68, 16, v70
    v_lshlrev_b32 v72, 16, v74
    v_and_b32 v69, 0xffff0000, v70
    v_and_b32 v73, 0xffff0000, v74
    v_pk_add_f32 v[68:69], v[68:69], v[56:57] op_sel:[0,1] op_sel_hi:[1,1]
    v_pk_add_f32 v[72:73], v[72:73], v[56:57] op_sel:[0,1] op_sel_hi:[1,1]
    v_cvt_pk_bf16_f32 v70, v68, v69
    v_cvt_pk_bf16_f32 v74, v72, v73
    v_lshlrev_b32 v68, 16, v70
    v_lshlrev_b32 v72, 16, v74
    v_and_b32 v69, 0xffff0000, v70
    v_and_b32 v73, 0xffff0000, v74
    v_pk_mul_f32 v[70:71], v[68:69], v[68:69]
    v_pk_mul_f32 v[74:75], v[72:73], v[72:73]
    v_pk_fma_f32 v[70:71], v[70:71], v[62:63], v[62:63] op_sel:[0,1,0] op_sel_hi:[1,1,0]
    v_pk_fma_f32 v[74:75], v[74:75], v[62:63], v[62:63] op_sel:[0,1,0] op_sel_hi:[1,1,0]
    v_pk_mul_f32 v[70:71], v[70:71], v[68:69]
    v_pk_mul_f32 v[74:75], v[74:75], v[72:73]
    v_exp_f32 v70, v70
    v_exp_f32 v74, v74
    v_exp_f32 v71, v71
    v_exp_f32 v75, v75
    v_pk_add_f32 v[70:71], v[70:71], 1.0 op_sel_hi:[1,0]
    v_pk_add_f32 v[74:75], v[74:75], 1.0 op_sel_hi:[1,0]
    v_rcp_f32 v70, v70
    v_rcp_f32 v74, v74
    v_rcp_f32 v71, v71
    v_rcp_f32 v75, v75
    v_pk_mul_f32 v[68:69], v[68:69], v[70:71]
    v_pk_mul_f32 v[72:73], v[72:73], v[74:75]
    v_cvt_pk_bf16_f32 v70, v68, v69
    v_cvt_pk_bf16_f32 v74, v72, v73
    v_lshlrev_b32 v68, 16, v70
    v_lshlrev_b32 v72, 16, v74
    v_and_b32 v69, 0xffff0000, v70
    v_and_b32 v73, 0xffff0000, v74
    v_pk_fma_f32 v[64:65], v[68:69], v[60:61], v[64:65] op_sel:[0,0,0] op_sel_hi:[1,0,1]
    v_pk_fma_f32 v[66:67], v[72:73], v[60:61], v[66:67] op_sel:[0,0,0] op_sel_hi:[1,0,1]
    s_nop 1
    v_permlane32_swap_b32 v64, v65
    v_permlane32_swap_b32 v66, v67
    v_add_f32 v64, v64, v65
    v_add_f32 v66, v66, v67
    s_nop 1
    v_permlane16_swap_b32 v64, v66
    v_add_f32 v64, v64, v66
    s_nop 1
    v_add_f32_dpp v64, v64, v64 quad_perm:[1,0,3,2] row_mask:0xf bank_mask:0xf
    s_nop 1
    v_add_f32_dpp v64, v64, v64 quad_perm:[2,3,0,1] row_mask:0xf bank_mask:0xf
    s_nop 1
    v_add_f32_dpp v64, v64, v64 row_half_mirror row_mask:0xf bank_mask:0xf
    s_nop 1
    v_add_f32_dpp v64, v64, v64 row_mirror row_mask:0xf bank_mask:0xf
    s_mov_b32 exec_lo, 0x00010001
    s_mov_b32 exec_hi, 0x00010001
    ds_write_b32 v49, v64 offset:13344
    s_mov_b64 exec, -1
    v_mov_b32 v42, 0
    s_waitcnt vmcnt(3)
    buffer_load_dwordx4 v[124:127], v1, s[32:35], s64 offen offset:0 nt
    s_waitcnt vmcnt(3)
    buffer_load_dwordx4 v[128:131], v1, s[32:35], s64 offen offset:128 nt
    s_waitcnt vmcnt(3)
    buffer_load_dwordx4 v[132:135], v1, s[32:35], s64 offen offset:256 nt
    s_add_u32 s64, s64, 3072
    s_cmp_eq_u32 s64, s15
    s_cselect_b32 s64, s14, s64
    v_dot2c_f32_bf16 v42, v112, v8
    v_dot2c_f32_bf16 v42, v113, v9
    v_add_f32_dpp v41, v41, v41 quad_perm:[1,0,3,2] row_mask:0xf bank_mask:0xf
    v_dot2c_f32_bf16 v42, v114, v10
    v_dot2c_f32_bf16 v42, v115, v11
    v_add_f32_dpp v41, v41, v41 quad_perm:[2,3,0,1] row_mask:0xf bank_mask:0xf
    v_dot2c_f32_bf16 v42, v116, v12
    v_dot2c_f32_bf16 v42, v117, v13
    v_add_f32_dpp v41, v41, v41 row_half_mirror row_mask:0xf bank_mask:0xf
    v_dot2c_f32_bf16 v42, v118, v14
    v_dot2c_f32_bf16 v42, v119, v15
    v_cvt_pk_bf16_f32 v41, v41, v41
    v_dot2c_f32_bf16 v42, v120, v16
    v_and_b32 v41, 0xffff0000, v41
    v_dot2c_f32_bf16 v42, v121, v17
    v_mul_f32 v41, 0x3d93cd3a, v41
    v_dot2c_f32_bf16 v42, v122, v18
    v_cvt_pk_bf16_f32 v41, v41, v41
    v_dot2c_f32_bf16 v42, v123, v19
    v_and_b32 v41, 0xffff0000, v41
    s_add_u32 s76, s100, 786432
    s_add_u32 s77, s100, 851968
    s_add_u32 s78, s100, 917504
    s_add_u32 s79, s100, 983040
    v_pk_mul_f32 v[68:69], s[76:77], v[52:53] op_sel:[0,0] op_sel_hi:[1,0]
    v_pk_mul_f32 v[72:73], s[78:79], v[52:53] op_sel:[0,0] op_sel_hi:[1,0]
    v_cvt_pk_bf16_f32 v70, v68, v69
    v_cvt_pk_bf16_f32 v74, v72, v73
    v_lshlrev_b32 v68, 16, v70
    v_lshlrev_b32 v72, 16, v74
    v_and_b32 v69, 0xffff0000, v70
    v_and_b32 v73, 0xffff0000, v74
    v_pk_add_f32 v[68:69], v[68:69], v[54:55] op_sel:[0,1] op_sel_hi:[1,1]
    v_pk_add_f32 v[72:73], v[72:73], v[54:55] op_sel:[0,1] op_sel_hi:[1,1]
    v_cvt_pk_bf16_f32 v70, v68, v69
    v_cvt_pk_bf16_f32 v74, v72, v73
    v_lshlrev_b32 v68, 16, v70
    v_lshlrev_b32 v72, 16, v74
    v_and_b32 v69, 0xffff0000, v70
    v_and_b32 v73, 0xffff0000, v74
    v_pk_mul_f32 v[70:71], v[68:69], v[68:69]
    v_pk_mul_f32 v[74:75], v[72:73], v[72:73]
    v_pk_fma_f32 v[70:71], v[70:71], v[62:63], v[62:63] op_sel:[0,1,0] op_sel_hi:[1,1,0]
    v_pk_fma_f32 v[74:75], v[74:75], v[62:63], v[62:63] op_sel:[0,1,0] op_sel_hi:[1,1,0]
    v_pk_mul_f32 v[70:71], v[70:71], v[68:69]
    v_pk_mul_f32 v[74:75], v[74:75], v[72:73]
    v_exp_f32 v70, v70
    v_exp_f32 v74, v74
    v_exp_f32 v71, v71
    v_exp_f32 v75, v75
    v_pk_add_f32 v[70:71], v[70:71], 1.0 op_sel_hi:[1,0]
    v_pk_add_f32 v[74:75], v[74:75], 1.0 op_sel_hi:[1,0]
    v_rcp_f32 v70, v70
    v_rcp_f32 v74, v74
    v_rcp_f32 v71, v71
    v_rcp_f32 v75, v75
    v_pk_mul_f32 v[68:69], v[68:69], v[70:71]
    v_pk_mul_f32 v[72:73], v[72:73], v[74:75]
    v_cvt_pk_bf16_f32 v70, v68, v69
    v_cvt_pk_bf16_f32 v74, v72, v73
    v_lshlrev_b32 v68, 16, v70
    v_lshlrev_b32 v72, 16, v74
    v_and_b32 v69, 0xffff0000, v70
    v_and_b32 v73, 0xffff0000, v74
    v_pk_mul_f32 v[64:65], v[68:69], v[58:59] op_sel:[0,0] op_sel_hi:[1,0]
    v_pk_mul_f32 v[66:67], v[72:73], v[58:59] op_sel:[0,0] op_sel_hi:[1,0]
    v_pk_mul_f32 v[68:69], s[76:77], v[52:53] op_sel:[0,1] op_sel_hi:[1,1]
    v_pk_mul_f32 v[72:73], s[78:79], v[52:53] op_sel:[0,1] op_sel_hi:[1,1]
    v_cvt_pk_bf16_f32 v70, v68, v69
    v_cvt_pk_bf16_f32 v74, v72, v73
    v_lshlrev_b32 v68, 16, v70
    v_lshlrev_b32 v72, 16, v74
    v_and_b32 v69, 0xffff0000, v70
    v_and_b32 v73, 0xffff0000, v74
    v_pk_add_f32 v[68:69], v[68:69], v[56:57] op_sel:[0,0] op_sel_hi:[1,0]
    v_pk_add_f32 v[72:73], v[72:73], v[56:57] op_sel:[0,0] op_sel_hi:[1,0]
    v_cvt_pk_bf16_f32 v70, v68, v69
    v_cvt_pk_bf16_f32 v74, v72, v73
    v_lshlrev_b32 v68, 16, v70
    v_lshlrev_b32 v72, 16, v74
    v_and_b32 v69, 0xffff0000, v70
    v_and_b32 v73, 0xffff0000, v74
    v_pk_mul_f32 v[70:71], v[68:69], v[68:69]
    v_pk_mul_f32 v[74:75], v[72:73], v[72:73]
    v_pk_fma_f32 v[70:71], v[70:71], v[62:63], v[62:63] op_sel:[0,1,0] op_sel_hi:[1,1,0]
    v_pk_fma_f32 v[74:75], v[74:75], v[62:63], v[62:63] op_sel:[0,1,0] op_sel_hi:[1,1,0]
    v_pk_mul_f32 v[70:71], v[70:71], v[68:69]
    v_pk_mul_f32 v[74:75], v[74:75], v[72:73]
    v_exp_f32 v70, v70
    v_exp_f32 v74, v74
    v_exp_f32 v71, v71
    v_exp_f32 v75, v75
    v_pk_add_f32 v[70:71], v[70:71], 1.0 op_sel_hi:[1,0]
    v_pk_add_f32 v[74:75], v[74:75], 1.0 op_sel_hi:[1,0]
    v_rcp_f32 v70, v70
    v_rcp_f32 v74, v74
    v_rcp_f32 v71, v71
    v_rcp_f32 v75, v75
    v_pk_mul_f32 v[68:69], v[68:69], v[70:71]
    v_pk_mul_f32 v[72:73], v[72:73], v[74:75]
    v_cvt_pk_bf16_f32 v70, v68, v69
    v_cvt_pk_bf16_f32 v74, v72, v73
    v_lshlrev_b32 v68, 16, v70
    v_lshlrev_b32 v72, 16, v74
    v_and_b32 v69, 0xffff0000, v70
    v_and_b32 v73, 0xffff0000, v74
    v_pk_fma_f32 v[64:65], v[68:69], v[58:59], v[64:65] op_sel:[0,1,0] op_sel_hi:[1,1,1]
    v_pk_fma_f32 v[66:67], v[72:73], v[58:59], v[66:67] op_sel:[0,1,0] op_sel_hi:[1,1,1]
    v_mov_b32 v43, 0
    s_waitcnt vmcnt(2)
    buffer_load_dwordx4 v[76:79], v1, s[32:35], s64 offen offset:0 nt
    s_waitcnt vmcnt(2)
    buffer_load_dwordx4 v[80:83], v1, s[32:35], s64 offen offset:128 nt
    s_waitcnt vmcnt(2)
    buffer_load_dwordx4 v[84:87], v1, s[32:35], s64 offen offset:256 nt
    s_add_u32 s64, s64, 3072
    s_cmp_eq_u32 s64, s15
    s_cselect_b32 s64, s14, s64
    v_dot2c_f32_bf16 v43, v124, v8
    v_dot2c_f32_bf16 v43, v125, v9
    v_add_f32_dpp v42, v42, v42 quad_perm:[1,0,3,2] row_mask:0xf bank_mask:0xf
    v_dot2c_f32_bf16 v43, v126, v10
    v_dot2c_f32_bf16 v43, v127, v11
    v_add_f32_dpp v42, v42, v42 quad_perm:[2,3,0,1] row_mask:0xf bank_mask:0xf
    v_dot2c_f32_bf16 v43, v128, v12
    v_dot2c_f32_bf16 v43, v129, v13
    v_add_f32_dpp v42, v42, v42 row_half_mirror row_mask:0xf bank_mask:0xf
    v_dot2c_f32_bf16 v43, v130, v14
    v_dot2c_f32_bf16 v43, v131, v15
    v_cvt_pk_bf16_f32 v42, v42, v42
    v_dot2c_f32_bf16 v43, v132, v16
    v_and_b32 v42, 0xffff0000, v42
    v_dot2c_f32_bf16 v43, v133, v17
    v_mul_f32 v42, 0x3d93cd3a, v42
    v_dot2c_f32_bf16 v43, v134, v18
    v_cvt_pk_bf16_f32 v42, v42, v42
    v_dot2c_f32_bf16 v43, v135, v19
    v_and_b32 v42, 0xffff0000, v42
    s_add_u32 s31, s30, 2560
    buffer_load_dwordx4 a[40:43], v7, s[44:47], s31 offen offset:0
    v_pk_mul_f32 v[68:69], s[76:77], v[54:55] op_sel:[0,0] op_sel_hi:[1,0]
    v_pk_mul_f32 v[72:73], s[78:79], v[54:55] op_sel:[0,0] op_sel_hi:[1,0]
    v_cvt_pk_bf16_f32 v70, v68, v69
    v_cvt_pk_bf16_f32 v74, v72, v73
    v_lshlrev_b32 v68, 16, v70
    v_lshlrev_b32 v72, 16, v74
    v_and_b32 v69, 0xffff0000, v70
    v_and_b32 v73, 0xffff0000, v74
    v_pk_add_f32 v[68:69], v[68:69], v[56:57] op_sel:[0,1] op_sel_hi:[1,1]
    v_pk_add_f32 v[72:73], v[72:73], v[56:57] op_sel:[0,1] op_sel_hi:[1,1]
    v_cvt_pk_bf16_f32 v70, v68, v69
    v_cvt_pk_bf16_f32 v74, v72, v73
    v_lshlrev_b32 v68, 16, v70
    v_lshlrev_b32 v72, 16, v74
    v_and_b32 v69, 0xffff0000, v70
    v_and_b32 v73, 0xffff0000, v74
    v_pk_mul_f32 v[70:71], v[68:69], v[68:69]
    v_pk_mul_f32 v[74:75], v[72:73], v[72:73]
    v_pk_fma_f32 v[70:71], v[70:71], v[62:63], v[62:63] op_sel:[0,1,0] op_sel_hi:[1,1,0]
    v_pk_fma_f32 v[74:75], v[74:75], v[62:63], v[62:63] op_sel:[0,1,0] op_sel_hi:[1,1,0]
    v_pk_mul_f32 v[70:71], v[70:71], v[68:69]
    v_pk_mul_f32 v[74:75], v[74:75], v[72:73]
    v_exp_f32 v70, v70
    v_exp_f32 v74, v74
    v_exp_f32 v71, v71
    v_exp_f32 v75, v75
    v_pk_add_f32 v[70:71], v[70:71], 1.0 op_sel_hi:[1,0]
    v_pk_add_f32 v[74:75], v[74:75], 1.0 op_sel_hi:[1,0]
    v_rcp_f32 v70, v70
    v_rcp_f32 v74, v74
    v_rcp_f32 v71, v71
    v_rcp_f32 v75, v75
    v_pk_mul_f32 v[68:69], v[68:69], v[70:71]
    v_pk_mul_f32 v[72:73], v[72:73], v[74:75]
    v_cvt_pk_bf16_f32 v70, v68, v69
    v_cvt_pk_bf16_f32 v74, v72, v73
    v_lshlrev_b32 v68, 16, v70
    v_lshlrev_b32 v72, 16, v74
    v_and_b32 v69, 0xffff0000, v70
    v_and_b32 v73, 0xffff0000, v74
    v_pk_fma_f32 v[64:65], v[68:69], v[60:61], v[64:65] op_sel:[0,0,0] op_sel_hi:[1,0,1]
    v_pk_fma_f32 v[66:67], v[72:73], v[60:61], v[66:67] op_sel:[0,0,0] op_sel_hi:[1,0,1]
    s_nop 1
    v_permlane32_swap_b32 v64, v65
    v_permlane32_swap_b32 v66, v67
    v_add_f32 v64, v64, v65
    v_add_f32 v66, v66, v67
    s_nop 1
    v_permlane16_swap_b32 v64, v66
    v_add_f32 v64, v64, v66
    s_nop 1
    v_add_f32_dpp v64, v64, v64 quad_perm:[1,0,3,2] row_mask:0xf bank_mask:0xf
    s_nop 1
    v_add_f32_dpp v64, v64, v64 quad_perm:[2,3,0,1] row_mask:0xf bank_mask:0xf
    s_nop 1
    v_add_f32_dpp v64, v64, v64 row_half_mirror row_mask:0xf bank_mask:0xf
    s_nop 1
    v_add_f32_dpp v64, v64, v64 row_mirror row_mask:0xf bank_mask:0xf
    s_mov_b32 exec_lo, 0x00010001
    s_mov_b32 exec_hi, 0x00010001
    ds_write_b32 v49, v64 offset:13360
    s_mov_b64 exec, -1
    v_mov_b32 v44, 0
    s_waitcnt vmcnt(3)
    buffer_load_dwordx4 v[88:91], v1, s[32:35], s64 offen offset:0 nt
    s_waitcnt vmcnt(3)
    buffer_load_dwordx4 v[92:95], v1, s[32:35], s64 offen offset:128 nt
    s_waitcnt vmcnt(3)
    buffer_load_dwordx4 v[96:99], v1, s[32:35], s64 offen offset:256 nt
    s_add_u32 s64, s64, 3072
    s_cmp_eq_u32 s64, s15
    s_cselect_b32 s64, s14, s64
    v_dot2c_f32_bf16 v44, v76, v8
    v_dot2c_f32_bf16 v44, v77, v9
    v_add_f32_dpp v43, v43, v43 quad_perm:[1,0,3,2] row_mask:0xf bank_mask:0xf
    v_dot2c_f32_bf16 v44, v78, v10
    v_dot2c_f32_bf16 v44, v79, v11
    v_add_f32_dpp v43, v43, v43 quad_perm:[2,3,0,1] row_mask:0xf bank_mask:0xf
    v_dot2c_f32_bf16 v44, v80, v12
    v_dot2c_f32_bf16 v44, v81, v13
    v_add_f32_dpp v43, v43, v43 row_half_mirror row_mask:0xf bank_mask:0xf
    v_dot2c_f32_bf16 v44, v82, v14
    v_dot2c_f32_bf16 v44, v83, v15
    v_cvt_pk_bf16_f32 v43, v43, v43
    v_dot2c_f32_bf16 v44, v84, v16
    v_and_b32 v43, 0xffff0000, v43
    v_dot2c_f32_bf16 v44, v85, v17
    v_mul_f32 v43, 0x3d93cd3a, v43
    v_dot2c_f32_bf16 v44, v86, v18
    v_cvt_pk_bf16_f32 v43, v43, v43
    v_dot2c_f32_bf16 v44, v87, v19
    v_and_b32 v43, 0xffff0000, v43
    s_add_u32 s31, s30, 17920
    buffer_load_dwordx4 a[44:47], v7, s[44:47], s31 offen offset:0
    s_add_u32 s76, s100, 1048576
    s_add_u32 s77, s100, 1114112
    s_add_u32 s78, s100, 1179648
    s_add_u32 s79, s100, 1245184
    v_pk_mul_f32 v[68:69], s[76:77], v[52:53] op_sel:[0,0] op_sel_hi:[1,0]
    v_pk_mul_f32 v[72:73], s[78:79], v[52:53] op_sel:[0,0] op_sel_hi:[1,0]
    v_cvt_pk_bf16_f32 v70, v68, v69
    v_cvt_pk_bf16_f32 v74, v72, v73
    v_lshlrev_b32 v68, 16, v70
    v_lshlrev_b32 v72, 16, v74
    v_and_b32 v69, 0xffff0000, v70
    v_and_b32 v73, 0xffff0000, v74
    v_pk_add_f32 v[68:69], v[68:69], v[54:55] op_sel:[0,1] op_sel_hi:[1,1]
    v_pk_add_f32 v[72:73], v[72:73], v[54:55] op_sel:[0,1] op_sel_hi:[1,1]
    v_cvt_pk_bf16_f32 v70, v68, v69
    v_cvt_pk_bf16_f32 v74, v72, v73
    v_lshlrev_b32 v68, 16, v70
    v_lshlrev_b32 v72, 16, v74
    v_and_b32 v69, 0xffff0000, v70
    v_and_b32 v73, 0xffff0000, v74
    v_pk_mul_f32 v[70:71], v[68:69], v[68:69]
    v_pk_mul_f32 v[74:75], v[72:73], v[72:73]
    v_pk_fma_f32 v[70:71], v[70:71], v[62:63], v[62:63] op_sel:[0,1,0] op_sel_hi:[1,1,0]
    v_pk_fma_f32 v[74:75], v[74:75], v[62:63], v[62:63] op_sel:[0,1,0] op_sel_hi:[1,1,0]
    v_pk_mul_f32 v[70:71], v[70:71], v[68:69]
    v_pk_mul_f32 v[74:75], v[74:75], v[72:73]
    v_exp_f32 v70, v70
    v_exp_f32 v74, v74
    v_exp_f32 v71, v71
    v_exp_f32 v75, v75
    v_pk_add_f32 v[70:71], v[70:71], 1.0 op_sel_hi:[1,0]
    v_pk_add_f32 v[74:75], v[74:75], 1.0 op_sel_hi:[1,0]
    v_rcp_f32 v70, v70
    v_rcp_f32 v74, v74
    v_rcp_f32 v71, v71
    v_rcp_f32 v75, v75
    v_pk_mul_f32 v[68:69], v[68:69], v[70:71]
    v_pk_mul_f32 v[72:73], v[72:73], v[74:75]
    v_cvt_pk_bf16_f32 v70, v68, v69
    v_cvt_pk_bf16_f32 v74, v72, v73
    v_lshlrev_b32 v68, 16, v70
    v_lshlrev_b32 v72, 16, v74
    v_and_b32 v69, 0xffff0000, v70
    v_and_b32 v73, 0xffff0000, v74
    v_pk_mul_f32 v[64:65], v[68:69], v[58:59] op_sel:[0,0] op_sel_hi:[1,0]
    v_pk_mul_f32 v[66:67], v[72:73], v[58:59] op_sel:[0,0] op_sel_hi:[1,0]
    v_pk_mul_f32 v[68:69], s[76:77], v[52:53] op_sel:[0,1] op_sel_hi:[1,1]
    v_pk_mul_f32 v[72:73], s[78:79], v[52:53] op_sel:[0,1] op_sel_hi:[1,1]
    v_cvt_pk_bf16_f32 v70, v68, v69
    v_cvt_pk_bf16_f32 v74, v72, v73
    v_lshlrev_b32 v68, 16, v70
    v_lshlrev_b32 v72, 16, v74
    v_and_b32 v69, 0xffff0000, v70
    v_and_b32 v73, 0xffff0000, v74
    v_pk_add_f32 v[68:69], v[68:69], v[56:57] op_sel:[0,0] op_sel_hi:[1,0]
    v_pk_add_f32 v[72:73], v[72:73], v[56:57] op_sel:[0,0] op_sel_hi:[1,0]
    v_cvt_pk_bf16_f32 v70, v68, v69
    v_cvt_pk_bf16_f32 v74, v72, v73
    v_lshlrev_b32 v68, 16, v70
    v_lshlrev_b32 v72, 16, v74
    v_and_b32 v69, 0xffff0000, v70
    v_and_b32 v73, 0xffff0000, v74
    v_pk_mul_f32 v[70:71], v[68:69], v[68:69]
    v_pk_mul_f32 v[74:75], v[72:73], v[72:73]
    v_pk_fma_f32 v[70:71], v[70:71], v[62:63], v[62:63] op_sel:[0,1,0] op_sel_hi:[1,1,0]
    v_pk_fma_f32 v[74:75], v[74:75], v[62:63], v[62:63] op_sel:[0,1,0] op_sel_hi:[1,1,0]
    v_pk_mul_f32 v[70:71], v[70:71], v[68:69]
    v_pk_mul_f32 v[74:75], v[74:75], v[72:73]
    v_exp_f32 v70, v70
    v_exp_f32 v74, v74
    v_exp_f32 v71, v71
    v_exp_f32 v75, v75
    v_pk_add_f32 v[70:71], v[70:71], 1.0 op_sel_hi:[1,0]
    v_pk_add_f32 v[74:75], v[74:75], 1.0 op_sel_hi:[1,0]
    v_rcp_f32 v70, v70
    v_rcp_f32 v74, v74
    v_rcp_f32 v71, v71
    v_rcp_f32 v75, v75
    v_pk_mul_f32 v[68:69], v[68:69], v[70:71]
    v_pk_mul_f32 v[72:73], v[72:73], v[74:75]
    v_cvt_pk_bf16_f32 v70, v68, v69
    v_cvt_pk_bf16_f32 v74, v72, v73
    v_lshlrev_b32 v68, 16, v70
    v_lshlrev_b32 v72, 16, v74
    v_and_b32 v69, 0xffff0000, v70
    v_and_b32 v73, 0xffff0000, v74
    v_pk_fma_f32 v[64:65], v[68:69], v[58:59], v[64:65] op_sel:[0,1,0] op_sel_hi:[1,1,1]
    v_pk_fma_f32 v[66:67], v[72:73], v[58:59], v[66:67] op_sel:[0,1,0] op_sel_hi:[1,1,1]
    v_mov_b32 v45, 0
    s_waitcnt vmcnt(3)
    buffer_load_dwordx4 v[100:103], v1, s[32:35], s64 offen offset:0 nt
    s_waitcnt vmcnt(3)
    buffer_load_dwordx4 v[104:107], v1, s[32:35], s64 offen offset:128 nt
    s_waitcnt vmcnt(3)
    buffer_load_dwordx4 v[108:111], v1, s[32:35], s64 offen offset:256 nt
    s_add_u32 s64, s64, 3072
    s_cmp_eq_u32 s64, s15
    s_cselect_b32 s64, s14, s64
    v_dot2c_f32_bf16 v45, v88, v8
    v_dot2c_f32_bf16 v45, v89, v9
    v_add_f32_dpp v44, v44, v44 quad_perm:[1,0,3,2] row_mask:0xf bank_mask:0xf
    v_dot2c_f32_bf16 v45, v90, v10
    v_dot2c_f32_bf16 v45, v91, v11
    v_add_f32_dpp v44, v44, v44 quad_perm:[2,3,0,1] row_mask:0xf bank_mask:0xf
    v_dot2c_f32_bf16 v45, v92, v12
    v_dot2c_f32_bf16 v45, v93, v13
    v_add_f32_dpp v44, v44, v44 row_half_mirror row_mask:0xf bank_mask:0xf
    v_dot2c_f32_bf16 v45, v94, v14
    v_dot2c_f32_bf16 v45, v95, v15
    v_cvt_pk_bf16_f32 v44, v44, v44
    v_dot2c_f32_bf16 v45, v96, v16
    v_and_b32 v44, 0xffff0000, v44
    v_dot2c_f32_bf16 v45, v97, v17
    v_mul_f32 v44, 0x3d93cd3a, v44
    v_dot2c_f32_bf16 v45, v98, v18
    v_cvt_pk_bf16_f32 v44, v44, v44
    v_dot2c_f32_bf16 v45, v99, v19
    v_and_b32 v44, 0xffff0000, v44
    s_add_u32 s31, s30, 2560
    buffer_load_dwordx4 a[48:51], v7, s[44:47], s31 offen offset:256
    v_pk_mul_f32 v[68:69], s[76:77], v[54:55] op_sel:[0,0] op_sel_hi:[1,0]
    v_pk_mul_f32 v[72:73], s[78:79], v[54:55] op_sel:[0,0] op_sel_hi:[1,0]
    v_cvt_pk_bf16_f32 v70, v68, v69
    v_cvt_pk_bf16_f32 v74, v72, v73
    v_lshlrev_b32 v68, 16, v70
    v_lshlrev_b32 v72, 16, v74
    v_and_b32 v69, 0xffff0000, v70
    v_and_b32 v73, 0xffff0000, v74
    v_pk_add_f32 v[68:69], v[68:69], v[56:57] op_sel:[0,1] op_sel_hi:[1,1]
    v_pk_add_f32 v[72:73], v[72:73], v[56:57] op_sel:[0,1] op_sel_hi:[1,1]
    v_cvt_pk_bf16_f32 v70, v68, v69
    v_cvt_pk_bf16_f32 v74, v72, v73
    v_lshlrev_b32 v68, 16, v70
    v_lshlrev_b32 v72, 16, v74
    v_and_b32 v69, 0xffff0000, v70
    v_and_b32 v73, 0xffff0000, v74
    v_pk_mul_f32 v[70:71], v[68:69], v[68:69]
    v_pk_mul_f32 v[74:75], v[72:73], v[72:73]
    v_pk_fma_f32 v[70:71], v[70:71], v[62:63], v[62:63] op_sel:[0,1,0] op_sel_hi:[1,1,0]
    v_pk_fma_f32 v[74:75], v[74:75], v[62:63], v[62:63] op_sel:[0,1,0] op_sel_hi:[1,1,0]
    v_pk_mul_f32 v[70:71], v[70:71], v[68:69]
    v_pk_mul_f32 v[74:75], v[74:75], v[72:73]
    v_exp_f32 v70, v70
    v_exp_f32 v74, v74
    v_exp_f32 v71, v71
    v_exp_f32 v75, v75
    v_pk_add_f32 v[70:71], v[70:71], 1.0 op_sel_hi:[1,0]
    v_pk_add_f32 v[74:75], v[74:75], 1.0 op_sel_hi:[1,0]
    v_rcp_f32 v70, v70
    v_rcp_f32 v74, v74
    v_rcp_f32 v71, v71
    v_rcp_f32 v75, v75
    v_pk_mul_f32 v[68:69], v[68:69], v[70:71]
    v_pk_mul_f32 v[72:73], v[72:73], v[74:75]
    v_cvt_pk_bf16_f32 v70, v68, v69
    v_cvt_pk_bf16_f32 v74, v72, v73
    v_lshlrev_b32 v68, 16, v70
    v_lshlrev_b32 v72, 16, v74
    v_and_b32 v69, 0xffff0000, v70
    v_and_b32 v73, 0xffff0000, v74
    v_pk_fma_f32 v[64:65], v[68:69], v[60:61], v[64:65] op_sel:[0,0,0] op_sel_hi:[1,0,1]
    v_pk_fma_f32 v[66:67], v[72:73], v[60:61], v[66:67] op_sel:[0,0,0] op_sel_hi:[1,0,1]
    s_nop 1
    v_permlane32_swap_b32 v64, v65
    v_permlane32_swap_b32 v66, v67
    v_add_f32 v64, v64, v65
    v_add_f32 v66, v66, v67
    s_nop 1
    v_permlane16_swap_b32 v64, v66
    v_add_f32 v64, v64, v66
    s_nop 1
    v_add_f32_dpp v64, v64, v64 quad_perm:[1,0,3,2] row_mask:0xf bank_mask:0xf
    s_nop 1
    v_add_f32_dpp v64, v64, v64 quad_perm:[2,3,0,1] row_mask:0xf bank_mask:0xf
    s_nop 1
    v_add_f32_dpp v64, v64, v64 row_half_mirror row_mask:0xf bank_mask:0xf
    s_nop 1
    v_add_f32_dpp v64, v64, v64 row_mirror row_mask:0xf bank_mask:0xf
    s_mov_b32 exec_lo, 0x00010001
    s_mov_b32 exec_hi, 0x00010001
    ds_write_b32 v49, v64 offset:13376
    s_mov_b64 exec, -1
    v_mov_b32 v46, 0
    s_waitcnt vmcnt(3)
    buffer_load_dwordx4 v[112:115], v1, s[32:35], s64 offen offset:0 nt
    s_waitcnt vmcnt(3)
    buffer_load_dwordx4 v[116:119], v1, s[32:35], s64 offen offset:128 nt
    s_waitcnt vmcnt(3)
    buffer_load_dwordx4 v[120:123], v1, s[32:35], s64 offen offset:256 nt
    s_add_u32 s64, s64, 3072
    s_cmp_eq_u32 s64, s15
    s_cselect_b32 s64, s14, s64
    v_dot2c_f32_bf16 v46, v100, v8
    v_dot2c_f32_bf16 v46, v101, v9
    v_add_f32_dpp v45, v45, v45 quad_perm:[1,0,3,2] row_mask:0xf bank_mask:0xf
    v_dot2c_f32_bf16 v46, v102, v10
    v_dot2c_f32_bf16 v46, v103, v11
    v_add_f32_dpp v45, v45, v45 quad_perm:[2,3,0,1] row_mask:0xf bank_mask:0xf
    v_dot2c_f32_bf16 v46, v104, v12
    v_dot2c_f32_bf16 v46, v105, v13
    v_add_f32_dpp v45, v45, v45 row_half_mirror row_mask:0xf bank_mask:0xf
    v_dot2c_f32_bf16 v46, v106, v14
    v_dot2c_f32_bf16 v46, v107, v15
    v_cvt_pk_bf16_f32 v45, v45, v45
    v_dot2c_f32_bf16 v46, v108, v16
    v_and_b32 v45, 0xffff0000, v45
    v_dot2c_f32_bf16 v46, v109, v17
    v_mul_f32 v45, 0x3d93cd3a, v45
    v_dot2c_f32_bf16 v46, v110, v18
    v_cvt_pk_bf16_f32 v45, v45, v45
    v_dot2c_f32_bf16 v46, v111, v19
    v_and_b32 v45, 0xffff0000, v45
    s_add_u32 s76, s100, 1310720
    s_add_u32 s77, s100, 1376256
    s_add_u32 s78, s100, 1441792
    s_add_u32 s79, s100, 1507328
    s_cmp_eq_u32 s2, 127
    s_cselect_b32 s79, 0, s79
    v_pk_mul_f32 v[68:69], s[76:77], v[52:53] op_sel:[0,0] op_sel_hi:[1,0]
    v_pk_mul_f32 v[72:73], s[78:79], v[52:53] op_sel:[0,0] op_sel_hi:[1,0]
    v_cvt_pk_bf16_f32 v70, v68, v69
    v_cvt_pk_bf16_f32 v74, v72, v73
    v_lshlrev_b32 v68, 16, v70
    v_lshlrev_b32 v72, 16, v74
    v_and_b32 v69, 0xffff0000, v70
    v_and_b32 v73, 0xffff0000, v74
    v_pk_add_f32 v[68:69], v[68:69], v[54:55] op_sel:[0,1] op_sel_hi:[1,1]
    v_pk_add_f32 v[72:73], v[72:73], v[54:55] op_sel:[0,1] op_sel_hi:[1,1]
    v_cvt_pk_bf16_f32 v70, v68, v69
    v_cvt_pk_bf16_f32 v74, v72, v73
    v_lshlrev_b32 v68, 16, v70
    v_lshlrev_b32 v72, 16, v74
    v_and_b32 v69, 0xffff0000, v70
    v_and_b32 v73, 0xffff0000, v74
    v_pk_mul_f32 v[70:71], v[68:69], v[68:69]
    v_pk_mul_f32 v[74:75], v[72:73], v[72:73]
    v_pk_fma_f32 v[70:71], v[70:71], v[62:63], v[62:63] op_sel:[0,1,0] op_sel_hi:[1,1,0]
    v_pk_fma_f32 v[74:75], v[74:75], v[62:63], v[62:63] op_sel:[0,1,0] op_sel_hi:[1,1,0]
    v_pk_mul_f32 v[70:71], v[70:71], v[68:69]
    v_pk_mul_f32 v[74:75], v[74:75], v[72:73]
    v_exp_f32 v70, v70
    v_exp_f32 v74, v74
    v_exp_f32 v71, v71
    v_exp_f32 v75, v75
    v_pk_add_f32 v[70:71], v[70:71], 1.0 op_sel_hi:[1,0]
    v_pk_add_f32 v[74:75], v[74:75], 1.0 op_sel_hi:[1,0]
    v_rcp_f32 v70, v70
    v_rcp_f32 v74, v74
    v_rcp_f32 v71, v71
    v_rcp_f32 v75, v75
    v_pk_mul_f32 v[68:69], v[68:69], v[70:71]
    v_pk_mul_f32 v[72:73], v[72:73], v[74:75]
    v_cvt_pk_bf16_f32 v70, v68, v69
    v_cvt_pk_bf16_f32 v74, v72, v73
    v_lshlrev_b32 v68, 16, v70
    v_lshlrev_b32 v72, 16, v74
    v_and_b32 v69, 0xffff0000, v70
    v_and_b32 v73, 0xffff0000, v74
    v_pk_mul_f32 v[64:65], v[68:69], v[58:59] op_sel:[0,0] op_sel_hi:[1,0]
    v_pk_mul_f32 v[66:67], v[72:73], v[58:59] op_sel:[0,0] op_sel_hi:[1,0]
    v_pk_mul_f32 v[68:69], s[76:77], v[52:53] op_sel:[0,1] op_sel_hi:[1,1]
    v_pk_mul_f32 v[72:73], s[78:79], v[52:53] op_sel:[0,1] op_sel_hi:[1,1]
    v_cvt_pk_bf16_f32 v70, v68, v69
    v_cvt_pk_bf16_f32 v74, v72, v73
    v_lshlrev_b32 v68, 16, v70
    v_lshlrev_b32 v72, 16, v74
    v_and_b32 v69, 0xffff0000, v70
    v_and_b32 v73, 0xffff0000, v74
    v_pk_add_f32 v[68:69], v[68:69], v[56:57] op_sel:[0,0] op_sel_hi:[1,0]
    v_pk_add_f32 v[72:73], v[72:73], v[56:57] op_sel:[0,0] op_sel_hi:[1,0]
    v_cvt_pk_bf16_f32 v70, v68, v69
    v_cvt_pk_bf16_f32 v74, v72, v73
    v_lshlrev_b32 v68, 16, v70
    v_lshlrev_b32 v72, 16, v74
    v_and_b32 v69, 0xffff0000, v70
    v_and_b32 v73, 0xffff0000, v74
    v_pk_mul_f32 v[70:71], v[68:69], v[68:69]
    v_pk_mul_f32 v[74:75], v[72:73], v[72:73]
    v_pk_fma_f32 v[70:71], v[70:71], v[62:63], v[62:63] op_sel:[0,1,0] op_sel_hi:[1,1,0]
    v_pk_fma_f32 v[74:75], v[74:75], v[62:63], v[62:63] op_sel:[0,1,0] op_sel_hi:[1,1,0]
    v_pk_mul_f32 v[70:71], v[70:71], v[68:69]
    v_pk_mul_f32 v[74:75], v[74:75], v[72:73]
    v_exp_f32 v70, v70
    v_exp_f32 v74, v74
    v_exp_f32 v71, v71
    v_exp_f32 v75, v75
    v_pk_add_f32 v[70:71], v[70:71], 1.0 op_sel_hi:[1,0]
    v_pk_add_f32 v[74:75], v[74:75], 1.0 op_sel_hi:[1,0]
    v_rcp_f32 v70, v70
    v_rcp_f32 v74, v74
    v_rcp_f32 v71, v71
    v_rcp_f32 v75, v75
    v_pk_mul_f32 v[68:69], v[68:69], v[70:71]
    v_pk_mul_f32 v[72:73], v[72:73], v[74:75]
    v_cvt_pk_bf16_f32 v70, v68, v69
    v_cvt_pk_bf16_f32 v74, v72, v73
    v_lshlrev_b32 v68, 16, v70
    v_lshlrev_b32 v72, 16, v74
    v_and_b32 v69, 0xffff0000, v70
    v_and_b32 v73, 0xffff0000, v74
    v_pk_fma_f32 v[64:65], v[68:69], v[58:59], v[64:65] op_sel:[0,1,0] op_sel_hi:[1,1,1]
    v_pk_fma_f32 v[66:67], v[72:73], v[58:59], v[66:67] op_sel:[0,1,0] op_sel_hi:[1,1,1]
    v_mov_b32 v47, 0
    s_waitcnt vmcnt(2)
    buffer_load_dwordx4 v[124:127], v1, s[32:35], s64 offen offset:0 nt
    s_waitcnt vmcnt(2)
    buffer_load_dwordx4 v[128:131], v1, s[32:35], s64 offen offset:128 nt
    s_waitcnt vmcnt(2)
    buffer_load_dwordx4 v[132:135], v1, s[32:35], s64 offen offset:256 nt
    s_add_u32 s64, s64, 3072
    s_cmp_eq_u32 s64, s15
    s_cselect_b32 s64, s14, s64
    v_dot2c_f32_bf16 v47, v112, v8
    v_dot2c_f32_bf16 v47, v113, v9
    v_add_f32_dpp v46, v46, v46 quad_perm:[1,0,3,2] row_mask:0xf bank_mask:0xf
    v_dot2c_f32_bf16 v47, v114, v10
    v_dot2c_f32_bf16 v47, v115, v11
    v_add_f32_dpp v46, v46, v46 quad_perm:[2,3,0,1] row_mask:0xf bank_mask:0xf
    v_dot2c_f32_bf16 v47, v116, v12
    v_dot2c_f32_bf16 v47, v117, v13
    v_add_f32_dpp v46, v46, v46 row_half_mirror row_mask:0xf bank_mask:0xf
    v_dot2c_f32_bf16 v47, v118, v14
    v_dot2c_f32_bf16 v47, v119, v15
    v_cvt_pk_bf16_f32 v46, v46, v46
    v_dot2c_f32_bf16 v47, v120, v16
    v_and_b32 v46, 0xffff0000, v46
    v_dot2c_f32_bf16 v47, v121, v17
    v_mul_f32 v46, 0x3d93cd3a, v46
    v_dot2c_f32_bf16 v47, v122, v18
    v_cvt_pk_bf16_f32 v46, v46, v46
    v_dot2c_f32_bf16 v47, v123, v19
    v_and_b32 v46, 0xffff0000, v46
    s_add_u32 s31, s30, 17920
    buffer_load_dwordx4 a[52:55], v7, s[44:47], s31 offen offset:256
    v_pk_mul_f32 v[68:69], s[76:77], v[54:55] op_sel:[0,0] op_sel_hi:[1,0]
    v_pk_mul_f32 v[72:73], s[78:79], v[54:55] op_sel:[0,0] op_sel_hi:[1,0]
    v_cvt_pk_bf16_f32 v70, v68, v69
    v_cvt_pk_bf16_f32 v74, v72, v73
    v_lshlrev_b32 v68, 16, v70
    v_lshlrev_b32 v72, 16, v74
    v_and_b32 v69, 0xffff0000, v70
    v_and_b32 v73, 0xffff0000, v74
    v_pk_add_f32 v[68:69], v[68:69], v[56:57] op_sel:[0,1] op_sel_hi:[1,1]
    v_pk_add_f32 v[72:73], v[72:73], v[56:57] op_sel:[0,1] op_sel_hi:[1,1]
    v_cvt_pk_bf16_f32 v70, v68, v69
    v_cvt_pk_bf16_f32 v74, v72, v73
    v_lshlrev_b32 v68, 16, v70
    v_lshlrev_b32 v72, 16, v74
    v_and_b32 v69, 0xffff0000, v70
    v_and_b32 v73, 0xffff0000, v74
    v_pk_mul_f32 v[70:71], v[68:69], v[68:69]
    v_pk_mul_f32 v[74:75], v[72:73], v[72:73]
    v_pk_fma_f32 v[70:71], v[70:71], v[62:63], v[62:63] op_sel:[0,1,0] op_sel_hi:[1,1,0]
    v_pk_fma_f32 v[74:75], v[74:75], v[62:63], v[62:63] op_sel:[0,1,0] op_sel_hi:[1,1,0]
    v_pk_mul_f32 v[70:71], v[70:71], v[68:69]
    v_pk_mul_f32 v[74:75], v[74:75], v[72:73]
    v_exp_f32 v70, v70
    v_exp_f32 v74, v74
    v_exp_f32 v71, v71
    v_exp_f32 v75, v75
    v_pk_add_f32 v[70:71], v[70:71], 1.0 op_sel_hi:[1,0]
    v_pk_add_f32 v[74:75], v[74:75], 1.0 op_sel_hi:[1,0]
    v_rcp_f32 v70, v70
    v_rcp_f32 v74, v74
    v_rcp_f32 v71, v71
    v_rcp_f32 v75, v75
    v_pk_mul_f32 v[68:69], v[68:69], v[70:71]
    v_pk_mul_f32 v[72:73], v[72:73], v[74:75]
    v_cvt_pk_bf16_f32 v70, v68, v69
    v_cvt_pk_bf16_f32 v74, v72, v73
    v_lshlrev_b32 v68, 16, v70
    v_lshlrev_b32 v72, 16, v74
    v_and_b32 v69, 0xffff0000, v70
    v_and_b32 v73, 0xffff0000, v74
    v_pk_fma_f32 v[64:65], v[68:69], v[60:61], v[64:65] op_sel:[0,0,0] op_sel_hi:[1,0,1]
    v_pk_fma_f32 v[66:67], v[72:73], v[60:61], v[66:67] op_sel:[0,0,0] op_sel_hi:[1,0,1]
    s_nop 1
    v_permlane32_swap_b32 v64, v65
    v_permlane32_swap_b32 v66, v67
    v_add_f32 v64, v64, v65
    v_add_f32 v66, v66, v67
    s_nop 1
    v_permlane16_swap_b32 v64, v66
    v_add_f32 v64, v64, v66
    s_nop 1
    v_add_f32_dpp v64, v64, v64 quad_perm:[1,0,3,2] row_mask:0xf bank_mask:0xf
    s_nop 1
    v_add_f32_dpp v64, v64, v64 quad_perm:[2,3,0,1] row_mask:0xf bank_mask:0xf
    s_nop 1
    v_add_f32_dpp v64, v64, v64 row_half_mirror row_mask:0xf bank_mask:0xf
    s_nop 1
    v_add_f32_dpp v64, v64, v64 row_mirror row_mask:0xf bank_mask:0xf
    s_mov_b32 exec_lo, 0x00010001
    s_mov_b32 exec_hi, 0x00010001
    ds_write_b32 v49, v64 offset:13392
    s_mov_b64 exec, -1
    v_mov_b32 v68, 0
    v_mov_b32 v69, 1
    s_load_dword s67, s[22:23], 0
    s_waitcnt lgkmcnt(0)
    s_mov_b64 exec, 1
    ds_add_rtn_u32 v70, v68, v69 offset:13056
    s_waitcnt lgkmcnt(0)
    s_mov_b64 exec, -1
    v_readfirstlane_b32 s66, v70
    s_cmp_lg_u32 s66, 7
    s_cbranch_scc1 L_tfin_skip
    v_lshlrev_b32 v61, 2, v0
    s_mov_b32 exec_hi, 0
    ds_read_b32 v52, v61 offset:13312
    ds_read_b32 v53, v61 offset:13440
    ds_read_b32 v54, v61 offset:13568
    ds_read_b32 v55, v61 offset:13696
    ds_read_b32 v56, v61 offset:13824
    ds_read_b32 v57, v61 offset:13952
    ds_read_b32 v58, v61 offset:14080
    ds_read_b32 v59, v61 offset:14208
    s_lshl_b32 s67, s67, 16
    s_lshl_b32 s66, s2, 7
    s_add_u32 s66, s66, 425984
    v_and_b32 v68, 1, v0
    v_lshlrev_b32 v68, 4, v68
    v_lshrrev_b32 v68, v68, s98
    v_and_b32 v68, 0xffff, v68
    s_waitcnt lgkmcnt(0)
    v_add_f32 v52, v52, v56
    v_add_f32 v53, v53, v57
    v_add_f32 v54, v54, v58
    v_add_f32 v55, v55, v59
    v_add_f32 v52, v52, v54
    v_add_f32 v53, v53, v55
    v_add_f32 v52, v52, v53
    v_cvt_pk_bf16_f32 v52, v52, v52
    v_and_b32 v52, 0xffff0000, v52
    v_add_f32 v52, s67, v52
    v_cvt_pk_bf16_f32 v52, v52, v52
    v_lshl_or_b32 v52, v52, 16, v68
    buffer_store_dword v52, v61, s[48:51], s66 offen sc1
    s_mov_b64 exec, -1
L_tfin_skip:
    v_mov_b32 v48, 0
    s_waitcnt vmcnt(3)
    buffer_load_dwordx4 v[76:79], v1, s[32:35], s64 offen offset:0 nt
    s_waitcnt vmcnt(3)
    buffer_load_dwordx4 v[80:83], v1, s[32:35], s64 offen offset:128 nt
    s_waitcnt vmcnt(3)
    buffer_load_dwordx4 v[84:87], v1, s[32:35], s64 offen offset:256 nt
    s_add_u32 s64, s64, 3072
    s_cmp_eq_u32 s64, s15
    s_cselect_b32 s64, s14, s64
    v_dot2c_f32_bf16 v48, v124, v8
    v_dot2c_f32_bf16 v48, v125, v9
    v_add_f32_dpp v47, v47, v47 quad_perm:[1,0,3,2] row_mask:0xf bank_mask:0xf
    v_dot2c_f32_bf16 v48, v126, v10
    v_dot2c_f32_bf16 v48, v127, v11
    v_add_f32_dpp v47, v47, v47 quad_perm:[2,3,0,1] row_mask:0xf bank_mask:0xf
    v_dot2c_f32_bf16 v48, v128, v12
    v_dot2c_f32_bf16 v48, v129, v13
    v_add_f32_dpp v47, v47, v47 row_half_mirror row_mask:0xf bank_mask:0xf
    v_dot2c_f32_bf16 v48, v130, v14
    v_dot2c_f32_bf16 v48, v131, v15
    v_cvt_pk_bf16_f32 v47, v47, v47
    v_dot2c_f32_bf16 v48, v132, v16
    v_and_b32 v47, 0xffff0000, v47
    v_dot2c_f32_bf16 v48, v133, v17
    v_mul_f32 v47, 0x3d93cd3a, v47
    v_dot2c_f32_bf16 v48, v134, v18
    v_cvt_pk_bf16_f32 v47, v47, v47
    v_dot2c_f32_bf16 v48, v135, v19
    v_and_b32 v47, 0xffff0000, v47
    s_add_u32 s31, s30, 2560
    buffer_load_dwordx4 a[56:59], v7, s[44:47], s31 offen offset:512
    v_mov_b32 v49, 0
    s_waitcnt vmcnt(3)
    buffer_load_dwordx4 v[88:91], v1, s[32:35], s64 offen offset:0 nt
    s_waitcnt vmcnt(3)
    buffer_load_dwordx4 v[92:95], v1, s[32:35], s64 offen offset:128 nt
    s_waitcnt vmcnt(3)
    buffer_load_dwordx4 v[96:99], v1, s[32:35], s64 offen offset:256 nt
    s_add_u32 s64, s64, 3072
    s_cmp_eq_u32 s64, s15
    s_cselect_b32 s64, s14, s64
    v_dot2c_f32_bf16 v49, v76, v8
    v_dot2c_f32_bf16 v49, v77, v9
    v_add_f32_dpp v48, v48, v48 quad_perm:[1,0,3,2] row_mask:0xf bank_mask:0xf
    v_dot2c_f32_bf16 v49, v78, v10
    v_dot2c_f32_bf16 v49, v79, v11
    v_add_f32_dpp v48, v48, v48 quad_perm:[2,3,0,1] row_mask:0xf bank_mask:0xf
    v_dot2c_f32_bf16 v49, v80, v12
    v_dot2c_f32_bf16 v49, v81, v13
    v_add_f32_dpp v48, v48, v48 row_half_mirror row_mask:0xf bank_mask:0xf
    v_dot2c_f32_bf16 v49, v82, v14
    v_dot2c_f32_bf16 v49, v83, v15
    v_cvt_pk_bf16_f32 v48, v48, v48
    v_dot2c_f32_bf16 v49, v84, v16
    v_and_b32 v48, 0xffff0000, v48
    v_dot2c_f32_bf16 v49, v85, v17
    v_mul_f32 v48, 0x3d93cd3a, v48
    v_dot2c_f32_bf16 v49, v86, v18
    v_cvt_pk_bf16_f32 v48, v48, v48
    v_dot2c_f32_bf16 v49, v87, v19
    v_and_b32 v48, 0xffff0000, v48
    v_mov_b32 v50, 0
    s_waitcnt vmcnt(2)
    buffer_load_dwordx4 v[100:103], v1, s[32:35], s64 offen offset:0 nt
    s_waitcnt vmcnt(2)
    buffer_load_dwordx4 v[104:107], v1, s[32:35], s64 offen offset:128 nt
    s_waitcnt vmcnt(2)
    buffer_load_dwordx4 v[108:111], v1, s[32:35], s64 offen offset:256 nt
    v_dot2c_f32_bf16 v50, v88, v8
    v_dot2c_f32_bf16 v50, v89, v9
    v_add_f32_dpp v49, v49, v49 quad_perm:[1,0,3,2] row_mask:0xf bank_mask:0xf
    v_dot2c_f32_bf16 v50, v90, v10
    v_dot2c_f32_bf16 v50, v91, v11
    v_add_f32_dpp v49, v49, v49 quad_perm:[2,3,0,1] row_mask:0xf bank_mask:0xf
    v_dot2c_f32_bf16 v50, v92, v12
    v_dot2c_f32_bf16 v50, v93, v13
    v_add_f32_dpp v49, v49, v49 row_half_mirror row_mask:0xf bank_mask:0xf
    v_dot2c_f32_bf16 v50, v94, v14
    v_dot2c_f32_bf16 v50, v95, v15
    v_cvt_pk_bf16_f32 v49, v49, v49
    v_dot2c_f32_bf16 v50, v96, v16
    v_and_b32 v49, 0xffff0000, v49
    v_dot2c_f32_bf16 v50, v97, v17
    v_mul_f32 v49, 0x3d93cd3a, v49
    v_dot2c_f32_bf16 v50, v98, v18
    v_cvt_pk_bf16_f32 v49, v49, v49
    v_dot2c_f32_bf16 v50, v99, v19
    v_and_b32 v49, 0xffff0000, v49
    s_add_u32 s31, s30, 17920
    buffer_load_dwordx4 a[60:63], v7, s[44:47], s31 offen offset:512
    v_mov_b32 v51, 0
    s_waitcnt vmcnt(3)
    buffer_load_dwordx4 v[112:115], v2, s[36:39], s65 offen offset:0 nt
    s_waitcnt vmcnt(3)
    buffer_load_dwordx4 v[116:119], v2, s[36:39], s65 offen offset:256 nt
    s_waitcnt vmcnt(3)
    buffer_load_dwordx4 v[120:123], v2, s[36:39], s65 offen offset:512 nt
    s_add_u32 s65, s65, 3072
    s_cmp_eq_u32 s65, s15
    s_cselect_b32 s65, s14, s65
    v_dot2c_f32_bf16 v51, v100, v8
    v_dot2c_f32_bf16 v51, v101, v9
    v_add_f32_dpp v50, v50, v50 quad_perm:[1,0,3,2] row_mask:0xf bank_mask:0xf
    v_dot2c_f32_bf16 v51, v102, v10
    v_dot2c_f32_bf16 v51, v103, v11
    v_add_f32_dpp v50, v50, v50 quad_perm:[2,3,0,1] row_mask:0xf bank_mask:0xf
    v_dot2c_f32_bf16 v51, v104, v12
    v_dot2c_f32_bf16 v51, v105, v13
    v_add_f32_dpp v50, v50, v50 row_half_mirror row_mask:0xf bank_mask:0xf
    v_dot2c_f32_bf16 v51, v106, v14
    v_dot2c_f32_bf16 v51, v107, v15
    v_cvt_pk_bf16_f32 v50, v50, v50
    v_dot2c_f32_bf16 v51, v108, v16
    v_and_b32 v50, 0xffff0000, v50
    v_dot2c_f32_bf16 v51, v109, v17
    v_mul_f32 v50, 0x3d93cd3a, v50
    v_dot2c_f32_bf16 v51, v110, v18
    v_cvt_pk_bf16_f32 v50, v50, v50
    v_dot2c_f32_bf16 v51, v111, v19
    v_and_b32 v50, 0xffff0000, v50
    s_add_u32 s31, s30, 2560
    buffer_load_dwordx4 a[64:67], v7, s[44:47], s31 offen offset:768
    v_max3_f32 v72, v20, v21, v22
    v_max3_f32 v72, v72, v23, v24
    v_max3_f32 v72, v72, v25, v26
    v_add_f32_dpp v51, v51, v51 quad_perm:[1,0,3,2] row_mask:0xf bank_mask:0xf
    v_max3_f32 v72, v72, v27, v28
    v_max3_f32 v72, v72, v29, v30
    v_max3_f32 v72, v72, v31, v32
    v_add_f32_dpp v51, v51, v51 quad_perm:[2,3,0,1] row_mask:0xf bank_mask:0xf
    v_max3_f32 v72, v72, v33, v34
    v_max3_f32 v72, v72, v35, v36
    v_max3_f32 v72, v72, v37, v38
    v_add_f32_dpp v51, v51, v51 row_half_mirror row_mask:0xf bank_mask:0xf
    v_max3_f32 v72, v72, v39, v40
    v_cvt_pk_bf16_f32 v51, v51, v51
    v_max3_f32 v72, v72, v41, v42
    v_and_b32 v51, 0xffff0000, v51
    v_max3_f32 v72, v72, v43, v44
    v_mul_f32 v51, 0x3d93cd3a, v51
    v_max3_f32 v72, v72, v45, v46
    v_cvt_pk_bf16_f32 v51, v51, v51
    v_max3_f32 v72, v72, v47, v48
    v_and_b32 v51, 0xffff0000, v51
    v_max3_f32 v72, v72, v49, v50
    v_max_f32 v72, v72, v51
    s_nop 1
    v_max_f32_dpp v72, v72, v72 row_mirror row_mask:0xf bank_mask:0xf
    s_nop 1
    v_max_f32_dpp v72, v72, v72 row_bcast:15 row_mask:0xa bank_mask:0xf
    s_nop 1
    v_max_f32_dpp v72, v72, v72 row_bcast:31 row_mask:0xc bank_mask:0xf
    s_mov_b32 s59, 0x3fb8aa3b
    v_mul_f32 v72, s59, v72
    s_nop 0
    v_readlane_b32 s58, v72, 63
    s_nop 1
    v_mov_b32 v73, s58
    v_fma_f32 v20, v20, s59, -v73
    v_fma_f32 v21, v21, s59, -v73
    v_exp_f32 v20, v20
    v_exp_f32 v21, v21
    s_nop 0
    v_add_f32 v74, v20, v21
    v_cvt_pk_bf16_f32 v20, v20, v20
    v_cvt_pk_bf16_f32 v21, v21, v21
    v_and_b32 v64, v20, v3
    v_and_b32 v65, v20, v4
    v_and_b32 v66, v20, v5
    v_and_b32 v67, v20, v6
    s_waitcnt vmcnt(3)
    buffer_load_dwordx4 v[124:127], v2, s[36:39], s65 offen offset:0 nt
    s_waitcnt vmcnt(3)
    buffer_load_dwordx4 v[128:131], v2, s[36:39], s65 offen offset:256 nt
    s_waitcnt vmcnt(3)
    buffer_load_dwordx4 v[132:135], v2, s[36:39], s65 offen offset:512 nt
    s_add_u32 s65, s65, 3072
    s_cmp_eq_u32 s65, s15
    s_cselect_b32 s65, s14, s65
    s_nop 1
    v_mfma_f32_16x16x32_bf16 v[52:55], v[64:67], v[112:115], 0
    v_mfma_f32_16x16x32_bf16 v[56:59], v[64:67], v[116:119], 0
    v_mfma_f32_16x16x32_bf16 v[60:63], v[64:67], v[120:123], 0
    v_fma_f32 v22, v22, s59, -v73
    v_fma_f32 v23, v23, s59, -v73
    v_exp_f32 v22, v22
    v_exp_f32 v23, v23
    s_nop 0
    v_add_f32 v74, v74, v22
    v_add_f32 v74, v74, v23
    v_cvt_pk_bf16_f32 v22, v22, v22
    v_cvt_pk_bf16_f32 v23, v23, v23
    v_and_b32 v68, v21, v3
    v_and_b32 v69, v21, v4
    v_and_b32 v70, v21, v5
    v_and_b32 v71, v21, v6
    s_waitcnt vmcnt(2)
    buffer_load_dwordx4 v[76:79], v2, s[36:39], s65 offen offset:0 nt
    s_waitcnt vmcnt(2)
    buffer_load_dwordx4 v[80:83], v2, s[36:39], s65 offen offset:256 nt
    s_waitcnt vmcnt(2)
    buffer_load_dwordx4 v[84:87], v2, s[36:39], s65 offen offset:512 nt
    s_add_u32 s65, s65, 3072
    s_cmp_eq_u32 s65, s15
    s_cselect_b32 s65, s14, s65
    s_nop 1
    v_mfma_f32_16x16x32_bf16 v[52:55], v[68:71], v[124:127], v[52:55]
    v_mfma_f32_16x16x32_bf16 v[56:59], v[68:71], v[128:131], v[56:59]
    v_mfma_f32_16x16x32_bf16 v[60:63], v[68:71], v[132:135], v[60:63]
    s_add_u32 s31, s30, 17920
    buffer_load_dwordx4 a[68:71], v7, s[44:47], s31 offen offset:768
    v_fma_f32 v24, v24, s59, -v73
    v_fma_f32 v25, v25, s59, -v73
    v_exp_f32 v24, v24
    v_exp_f32 v25, v25
    s_nop 0
    v_add_f32 v74, v74, v24
    v_add_f32 v74, v74, v25
    v_cvt_pk_bf16_f32 v24, v24, v24
    v_cvt_pk_bf16_f32 v25, v25, v25
    v_and_b32 v64, v22, v3
    v_and_b32 v65, v22, v4
    v_and_b32 v66, v22, v5
    v_and_b32 v67, v22, v6
    s_waitcnt vmcnt(3)
    buffer_load_dwordx4 v[88:91], v2, s[36:39], s65 offen offset:0 nt
    s_waitcnt vmcnt(3)
    buffer_load_dwordx4 v[92:95], v2, s[36:39], s65 offen offset:256 nt
    s_waitcnt vmcnt(3)
    buffer_load_dwordx4 v[96:99], v2, s[36:39], s65 offen offset:512 nt
    s_add_u32 s65, s65, 3072
    s_cmp_eq_u32 s65, s15
    s_cselect_b32 s65, s14, s65
    s_nop 1
    v_mfma_f32_16x16x32_bf16 v[52:55], v[64:67], v[76:79], v[52:55]
    v_mfma_f32_16x16x32_bf16 v[56:59], v[64:67], v[80:83], v[56:59]
    v_mfma_f32_16x16x32_bf16 v[60:63], v[64:67], v[84:87], v[60:63]
    s_add_u32 s31, s30, 2560
    buffer_load_dwordx4 a[72:75], v7, s[44:47], s31 offen offset:1024
    v_fma_f32 v26, v26, s59, -v73
    v_fma_f32 v27, v27, s59, -v73
    v_exp_f32 v26, v26
    v_exp_f32 v27, v27
    s_nop 0
    v_add_f32 v74, v74, v26
    v_add_f32 v74, v74, v27
    v_cvt_pk_bf16_f32 v26, v26, v26
    v_cvt_pk_bf16_f32 v27, v27, v27
    v_and_b32 v68, v23, v3
    v_and_b32 v69, v23, v4
    v_and_b32 v70, v23, v5
    v_and_b32 v71, v23, v6
    s_waitcnt vmcnt(3)
    buffer_load_dwordx4 v[100:103], v2, s[36:39], s65 offen offset:0 nt
    s_waitcnt vmcnt(3)
    buffer_load_dwordx4 v[104:107], v2, s[36:39], s65 offen offset:256 nt
    s_waitcnt vmcnt(3)
    buffer_load_dwordx4 v[108:111], v2, s[36:39], s65 offen offset:512 nt
    s_add_u32 s65, s65, 3072
    s_cmp_eq_u32 s65, s15
    s_cselect_b32 s65, s14, s65
    s_nop 1
    v_mfma_f32_16x16x32_bf16 v[52:55], v[68:71], v[88:91], v[52:55]
    v_mfma_f32_16x16x32_bf16 v[56:59], v[68:71], v[92:95], v[56:59]
    v_mfma_f32_16x16x32_bf16 v[60:63], v[68:71], v[96:99], v[60:63]
    s_add_u32 s31, s30, 17920
    buffer_load_dwordx4 a[76:79], v7, s[44:47], s31 offen offset:1024
    v_fma_f32 v28, v28, s59, -v73
    v_fma_f32 v29, v29, s59, -v73
    v_exp_f32 v28, v28
    v_exp_f32 v29, v29
    s_nop 0
    v_add_f32 v74, v74, v28
    v_add_f32 v74, v74, v29
    v_cvt_pk_bf16_f32 v28, v28, v28
    v_cvt_pk_bf16_f32 v29, v29, v29
    v_and_b32 v64, v24, v3
    v_and_b32 v65, v24, v4
    v_and_b32 v66, v24, v5
    v_and_b32 v67, v24, v6
    s_waitcnt vmcnt(3)
    buffer_load_dwordx4 v[112:115], v2, s[36:39], s65 offen offset:0 nt
    s_waitcnt vmcnt(3)
    buffer_load_dwordx4 v[116:119], v2, s[36:39], s65 offen offset:256 nt
    s_waitcnt vmcnt(3)
    buffer_load_dwordx4 v[120:123], v2, s[36:39], s65 offen offset:512 nt
    s_add_u32 s65, s65, 3072
    s_cmp_eq_u32 s65, s15
    s_cselect_b32 s65, s14, s65
    s_nop 1
    v_mfma_f32_16x16x32_bf16 v[52:55], v[64:67], v[100:103], v[52:55]
    v_mfma_f32_16x16x32_bf16 v[56:59], v[64:67], v[104:107], v[56:59]
    v_mfma_f32_16x16x32_bf16 v[60:63], v[64:67], v[108:111], v[60:63]
    v_fma_f32 v30, v30, s59, -v73
    v_fma_f32 v31, v31, s59, -v73
    v_exp_f32 v30, v30
    v_exp_f32 v31, v31
    s_nop 0
    v_add_f32 v74, v74, v30
    v_add_f32 v74, v74, v31
    v_cvt_pk_bf16_f32 v30, v30, v30
    v_cvt_pk_bf16_f32 v31, v31, v31
    v_and_b32 v68, v25, v3
    v_and_b32 v69, v25, v4
    v_and_b32 v70, v25, v5
    v_and_b32 v71, v25, v6
    s_waitcnt vmcnt(2)
    buffer_load_dwordx4 v[124:127], v2, s[36:39], s65 offen offset:0 nt
    s_waitcnt vmcnt(2)
    buffer_load_dwordx4 v[128:131], v2, s[36:39], s65 offen offset:256 nt
    s_waitcnt vmcnt(2)
    buffer_load_dwordx4 v[132:135], v2, s[36:39], s65 offen offset:512 nt
    s_add_u32 s65, s65, 3072
    s_cmp_eq_u32 s65, s15
    s_cselect_b32 s65, s14, s65
    s_nop 1
    v_mfma_f32_16x16x32_bf16 v[52:55], v[68:71], v[112:115], v[52:55]
    v_mfma_f32_16x16x32_bf16 v[56:59], v[68:71], v[116:119], v[56:59]
    v_mfma_f32_16x16x32_bf16 v[60:63], v[68:71], v[120:123], v[60:63]
    s_add_u32 s31, s30, 5120
    buffer_load_dwordx4 a[80:83], v7, s[44:47], s31 offen offset:0
    v_fma_f32 v32, v32, s59, -v73
    v_fma_f32 v33, v33, s59, -v73
    v_exp_f32 v32, v32
    v_exp_f32 v33, v33
    s_nop 0
    v_add_f32 v74, v74, v32
    v_add_f32 v74, v74, v33
    v_cvt_pk_bf16_f32 v32, v32, v32
    v_cvt_pk_bf16_f32 v33, v33, v33
    v_and_b32 v64, v26, v3
    v_and_b32 v65, v26, v4
    v_and_b32 v66, v26, v5
    v_and_b32 v67, v26, v6
    s_waitcnt vmcnt(3)
    buffer_load_dwordx4 v[76:79], v2, s[36:39], s65 offen offset:0 nt
    s_waitcnt vmcnt(3)
    buffer_load_dwordx4 v[80:83], v2, s[36:39], s65 offen offset:256 nt
    s_waitcnt vmcnt(3)
    buffer_load_dwordx4 v[84:87], v2, s[36:39], s65 offen offset:512 nt
    s_add_u32 s65, s65, 3072
    s_cmp_eq_u32 s65, s15
    s_cselect_b32 s65, s14, s65
    s_nop 1
    v_mfma_f32_16x16x32_bf16 v[52:55], v[64:67], v[124:127], v[52:55]
    v_mfma_f32_16x16x32_bf16 v[56:59], v[64:67], v[128:131], v[56:59]
    v_mfma_f32_16x16x32_bf16 v[60:63], v[64:67], v[132:135], v[60:63]
    s_add_u32 s31, s30, 20480
    buffer_load_dwordx4 a[84:87], v7, s[44:47], s31 offen offset:0
    v_fma_f32 v34, v34, s59, -v73
    v_fma_f32 v35, v35, s59, -v73
    v_exp_f32 v34, v34
    v_exp_f32 v35, v35
    s_nop 0
    v_add_f32 v74, v74, v34
    v_add_f32 v74, v74, v35
    v_cvt_pk_bf16_f32 v34, v34, v34
    v_cvt_pk_bf16_f32 v35, v35, v35
    v_and_b32 v68, v27, v3
    v_and_b32 v69, v27, v4
    v_and_b32 v70, v27, v5
    v_and_b32 v71, v27, v6
    s_waitcnt vmcnt(3)
    buffer_load_dwordx4 v[88:91], v2, s[36:39], s65 offen offset:0 nt
    s_waitcnt vmcnt(3)
    buffer_load_dwordx4 v[92:95], v2, s[36:39], s65 offen offset:256 nt
    s_waitcnt vmcnt(3)
    buffer_load_dwordx4 v[96:99], v2, s[36:39], s65 offen offset:512 nt
    s_add_u32 s65, s65, 3072
    s_cmp_eq_u32 s65, s15
    s_cselect_b32 s65, s14, s65
    s_nop 1
    v_mfma_f32_16x16x32_bf16 v[52:55], v[68:71], v[76:79], v[52:55]
    v_mfma_f32_16x16x32_bf16 v[56:59], v[68:71], v[80:83], v[56:59]
    v_mfma_f32_16x16x32_bf16 v[60:63], v[68:71], v[84:87], v[60:63]
    v_fma_f32 v36, v36, s59, -v73
    v_fma_f32 v37, v37, s59, -v73
    v_exp_f32 v36, v36
    v_exp_f32 v37, v37
    s_nop 0
    v_add_f32 v74, v74, v36
    v_add_f32 v74, v74, v37
    v_cvt_pk_bf16_f32 v36, v36, v36
    v_cvt_pk_bf16_f32 v37, v37, v37
    v_and_b32 v64, v28, v3
    v_and_b32 v65, v28, v4
    v_and_b32 v66, v28, v5
    v_and_b32 v67, v28, v6
    s_waitcnt vmcnt(2)
    buffer_load_dwordx4 v[100:103], v2, s[36:39], s65 offen offset:0 nt
    s_waitcnt vmcnt(2)
    buffer_load_dwordx4 v[104:107], v2, s[36:39], s65 offen offset:256 nt
    s_waitcnt vmcnt(2)
    buffer_load_dwordx4 v[108:111], v2, s[36:39], s65 offen offset:512 nt
    s_add_u32 s65, s65, 3072
    s_cmp_eq_u32 s65, s15
    s_cselect_b32 s65, s14, s65
    s_nop 1
    v_mfma_f32_16x16x32_bf16 v[52:55], v[64:67], v[88:91], v[52:55]
    v_mfma_f32_16x16x32_bf16 v[56:59], v[64:67], v[92:95], v[56:59]
    v_mfma_f32_16x16x32_bf16 v[60:63], v[64:67], v[96:99], v[60:63]
    s_add_u32 s31, s30, 5120
    buffer_load_dwordx4 a[88:91], v7, s[44:47], s31 offen offset:256
    v_fma_f32 v38, v38, s59, -v73
    v_fma_f32 v39, v39, s59, -v73
    v_exp_f32 v38, v38
    v_exp_f32 v39, v39
    s_nop 0
    v_add_f32 v74, v74, v38
    v_add_f32 v74, v74, v39
    v_cvt_pk_bf16_f32 v38, v38, v38
    v_cvt_pk_bf16_f32 v39, v39, v39
    v_and_b32 v68, v29, v3
    v_and_b32 v69, v29, v4
    v_and_b32 v70, v29, v5
    v_and_b32 v71, v29, v6
    s_waitcnt vmcnt(3)
    buffer_load_dwordx4 v[112:115], v2, s[36:39], s65 offen offset:0 nt
    s_waitcnt vmcnt(3)
    buffer_load_dwordx4 v[116:119], v2, s[36:39], s65 offen offset:256 nt
    s_waitcnt vmcnt(3)
    buffer_load_dwordx4 v[120:123], v2, s[36:39], s65 offen offset:512 nt
    s_add_u32 s65, s65, 3072
    s_cmp_eq_u32 s65, s15
    s_cselect_b32 s65, s14, s65
    s_nop 1
    v_mfma_f32_16x16x32_bf16 v[52:55], v[68:71], v[100:103], v[52:55]
    v_mfma_f32_16x16x32_bf16 v[56:59], v[68:71], v[104:107], v[56:59]
    v_mfma_f32_16x16x32_bf16 v[60:63], v[68:71], v[108:111], v[60:63]
    s_add_u32 s31, s30, 20480
    buffer_load_dwordx4 a[92:95], v7, s[44:47], s31 offen offset:256
    v_fma_f32 v40, v40, s59, -v73
    v_fma_f32 v41, v41, s59, -v73
    v_exp_f32 v40, v40
    v_exp_f32 v41, v41
    s_nop 0
    v_add_f32 v74, v74, v40
    v_add_f32 v74, v74, v41
    v_cvt_pk_bf16_f32 v40, v40, v40
    v_cvt_pk_bf16_f32 v41, v41, v41
    v_and_b32 v64, v30, v3
    v_and_b32 v65, v30, v4
    v_and_b32 v66, v30, v5
    v_and_b32 v67, v30, v6
    s_waitcnt vmcnt(3)
    buffer_load_dwordx4 v[124:127], v2, s[36:39], s65 offen offset:0 nt
    s_waitcnt vmcnt(3)
    buffer_load_dwordx4 v[128:131], v2, s[36:39], s65 offen offset:256 nt
    s_waitcnt vmcnt(3)
    buffer_load_dwordx4 v[132:135], v2, s[36:39], s65 offen offset:512 nt
    s_add_u32 s65, s65, 3072
    s_cmp_eq_u32 s65, s15
    s_cselect_b32 s65, s14, s65
    s_nop 1
    v_mfma_f32_16x16x32_bf16 v[52:55], v[64:67], v[112:115], v[52:55]
    v_mfma_f32_16x16x32_bf16 v[56:59], v[64:67], v[116:119], v[56:59]
    v_mfma_f32_16x16x32_bf16 v[60:63], v[64:67], v[120:123], v[60:63]
    s_add_u32 s31, s30, 5120
    buffer_load_dwordx4 a[96:99], v7, s[44:47], s31 offen offset:512
    v_fma_f32 v42, v42, s59, -v73
    v_fma_f32 v43, v43, s59, -v73
    v_exp_f32 v42, v42
    v_exp_f32 v43, v43
    s_nop 0
    v_add_f32 v74, v74, v42
    v_add_f32 v74, v74, v43
    v_cvt_pk_bf16_f32 v42, v42, v42
    v_cvt_pk_bf16_f32 v43, v43, v43
    v_and_b32 v68, v31, v3
    v_and_b32 v69, v31, v4
    v_and_b32 v70, v31, v5
    v_and_b32 v71, v31, v6
    s_waitcnt vmcnt(3)
    buffer_load_dwordx4 v[76:79], v2, s[36:39], s65 offen offset:0 nt
    s_waitcnt vmcnt(3)
    buffer_load_dwordx4 v[80:83], v2, s[36:39], s65 offen offset:256 nt
    s_waitcnt vmcnt(3)
    buffer_load_dwordx4 v[84:87], v2, s[36:39], s65 offen offset:512 nt
    s_add_u32 s65, s65, 3072
    s_cmp_eq_u32 s65, s15
    s_cselect_b32 s65, s14, s65
    s_nop 1
    v_mfma_f32_16x16x32_bf16 v[52:55], v[68:71], v[124:127], v[52:55]
    v_mfma_f32_16x16x32_bf16 v[56:59], v[68:71], v[128:131], v[56:59]
    v_mfma_f32_16x16x32_bf16 v[60:63], v[68:71], v[132:135], v[60:63]
    v_fma_f32 v44, v44, s59, -v73
    v_fma_f32 v45, v45, s59, -v73
    v_exp_f32 v44, v44
    v_exp_f32 v45, v45
    s_nop 0
    v_add_f32 v74, v74, v44
    v_add_f32 v74, v74, v45
    v_cvt_pk_bf16_f32 v44, v44, v44
    v_cvt_pk_bf16_f32 v45, v45, v45
    v_and_b32 v64, v32, v3
    v_and_b32 v65, v32, v4
    v_and_b32 v66, v32, v5
    v_and_b32 v67, v32, v6
    s_waitcnt vmcnt(2)
    buffer_load_dwordx4 v[88:91], v2, s[36:39], s65 offen offset:0 nt
    s_waitcnt vmcnt(2)
    buffer_load_dwordx4 v[92:95], v2, s[36:39], s65 offen offset:256 nt
    s_waitcnt vmcnt(2)
    buffer_load_dwordx4 v[96:99], v2, s[36:39], s65 offen offset:512 nt
    s_add_u32 s65, s65, 3072
    s_cmp_eq_u32 s65, s15
    s_cselect_b32 s65, s14, s65
    s_nop 1
    v_mfma_f32_16x16x32_bf16 v[52:55], v[64:67], v[76:79], v[52:55]
    v_mfma_f32_16x16x32_bf16 v[56:59], v[64:67], v[80:83], v[56:59]
    v_mfma_f32_16x16x32_bf16 v[60:63], v[64:67], v[84:87], v[60:63]
    s_add_u32 s31, s30, 20480
    buffer_load_dwordx4 a[100:103], v7, s[44:47], s31 offen offset:512
    v_fma_f32 v46, v46, s59, -v73
    v_fma_f32 v47, v47, s59, -v73
    v_exp_f32 v46, v46
    v_exp_f32 v47, v47
    s_nop 0
    v_add_f32 v74, v74, v46
    v_add_f32 v74, v74, v47
    v_cvt_pk_bf16_f32 v46, v46, v46
    v_cvt_pk_bf16_f32 v47, v47, v47
    v_and_b32 v68, v33, v3
    v_and_b32 v69, v33, v4
    v_and_b32 v70, v33, v5
    v_and_b32 v71, v33, v6
    s_waitcnt vmcnt(3)
    buffer_load_dwordx4 v[100:103], v2, s[36:39], s65 offen offset:0 nt
    s_waitcnt vmcnt(3)
    buffer_load_dwordx4 v[104:107], v2, s[36:39], s65 offen offset:256 nt
    s_waitcnt vmcnt(3)
    buffer_load_dwordx4 v[108:111], v2, s[36:39], s65 offen offset:512 nt
    s_add_u32 s65, s65, 3072
    s_cmp_eq_u32 s65, s15
    s_cselect_b32 s65, s14, s65
    s_nop 1
    v_mfma_f32_16x16x32_bf16 v[52:55], v[68:71], v[88:91], v[52:55]
    v_mfma_f32_16x16x32_bf16 v[56:59], v[68:71], v[92:95], v[56:59]
    v_mfma_f32_16x16x32_bf16 v[60:63], v[68:71], v[96:99], v[60:63]
    s_add_u32 s31, s30, 5120
    buffer_load_dwordx4 a[104:107], v7, s[44:47], s31 offen offset:768
    v_fma_f32 v48, v48, s59, -v73
    v_fma_f32 v49, v49, s59, -v73
    v_exp_f32 v48, v48
    v_exp_f32 v49, v49
    s_nop 0
    v_add_f32 v74, v74, v48
    v_add_f32 v74, v74, v49
    v_cvt_pk_bf16_f32 v48, v48, v48
    v_cvt_pk_bf16_f32 v49, v49, v49
    v_and_b32 v64, v34, v3
    v_and_b32 v65, v34, v4
    v_and_b32 v66, v34, v5
    v_and_b32 v67, v34, v6
    s_waitcnt vmcnt(3)
    buffer_load_dwordx4 v[112:115], v2, s[36:39], s65 offen offset:0 nt
    s_waitcnt vmcnt(3)
    buffer_load_dwordx4 v[116:119], v2, s[36:39], s65 offen offset:256 nt
    s_waitcnt vmcnt(3)
    buffer_load_dwordx4 v[120:123], v2, s[36:39], s65 offen offset:512 nt
    s_add_u32 s65, s65, 3072
    s_cmp_eq_u32 s65, s15
    s_cselect_b32 s65, s14, s65
    s_nop 1
    v_mfma_f32_16x16x32_bf16 v[52:55], v[64:67], v[100:103], v[52:55]
    v_mfma_f32_16x16x32_bf16 v[56:59], v[64:67], v[104:107], v[56:59]
    v_mfma_f32_16x16x32_bf16 v[60:63], v[64:67], v[108:111], v[60:63]
    v_fma_f32 v50, v50, s59, -v73
    v_fma_f32 v51, v51, s59, -v73
    v_exp_f32 v50, v50
    v_exp_f32 v51, v51
    s_nop 0
    v_add_f32 v74, v74, v50
    v_add_f32 v74, v74, v51
    v_and_b32 v68, v35, v3
    v_and_b32 v69, v35, v4
    v_and_b32 v70, v35, v5
    v_and_b32 v71, v35, v6
    s_waitcnt vmcnt(2)
    buffer_load_dwordx4 v[124:127], v2, s[36:39], s65 offen offset:0 nt
    s_waitcnt vmcnt(2)
    buffer_load_dwordx4 v[128:131], v2, s[36:39], s65 offen offset:256 nt
    s_waitcnt vmcnt(2)
    buffer_load_dwordx4 v[132:135], v2, s[36:39], s65 offen offset:512 nt
    s_add_u32 s65, s65, 3072
    s_cmp_eq_u32 s65, s15
    s_cselect_b32 s65, s14, s65
    s_nop 1
    v_mfma_f32_16x16x32_bf16 v[52:55], v[68:71], v[112:115], v[52:55]
    v_mfma_f32_16x16x32_bf16 v[56:59], v[68:71], v[116:119], v[56:59]
    v_mfma_f32_16x16x32_bf16 v[60:63], v[68:71], v[120:123], v[60:63]
    s_add_u32 s31, s30, 20480
    buffer_load_dwordx4 a[108:111], v7, s[44:47], s31 offen offset:768
    s_nop 1
    v_add_f32_dpp v74, v74, v74 row_mirror row_mask:0xf bank_mask:0xf
    s_nop 1
    v_add_f32_dpp v74, v74, v74 row_bcast:15 row_mask:0xa bank_mask:0xf
    s_nop 1
    v_add_f32_dpp v74, v74, v74 row_bcast:31 row_mask:0xc bank_mask:0xf
    v_mov_b32 v8, v73
    v_mov_b32 v9, s98
    v_mov_b32 v10, v74
    v_mov_b32 v11, s99
    v_mov_b32 v12, 0
    v_lshlrev_b32 v19, 4, v0
    s_lshl_b32 s66, s3, 4
    v_mov_b32 v72, s66
    v_mov_b32 v75, 1
    s_mov_b32 exec_lo, 0
    s_mov_b32 exec_hi, 0x80000000
    ds_write_b128 v72, v[8:11] offset:13184
    ds_add_rtn_u32 v75, v12, v75 offset:13060
    s_waitcnt lgkmcnt(0)
    v_readfirstlane_b32 s66, v75
    s_mov_b64 exec, 0xff
    s_cmp_lg_u32 s66, 7
    s_cbranch_scc1 L_mlskip
    ds_read_b128 v[8:11], v19 offset:13184
    s_waitcnt lgkmcnt(0)
    buffer_store_dwordx4 v[8:11], v19, s[48:51], s56 offen sc1
L_mlskip:
    s_mov_b64 exec, -1
    v_and_b32 v64, v36, v3
    v_and_b32 v65, v36, v4
    v_and_b32 v66, v36, v5
    v_and_b32 v67, v36, v6
    s_waitcnt vmcnt(3)
    buffer_load_dwordx4 v[76:79], v2, s[36:39], s65 offen offset:0 nt
    s_waitcnt vmcnt(3)
    buffer_load_dwordx4 v[80:83], v2, s[36:39], s65 offen offset:256 nt
    s_waitcnt vmcnt(3)
    buffer_load_dwordx4 v[84:87], v2, s[36:39], s65 offen offset:512 nt
    s_add_u32 s65, s65, 3072
    s_cmp_eq_u32 s65, s15
    s_cselect_b32 s65, s14, s65
    s_nop 1
    v_mfma_f32_16x16x32_bf16 v[52:55], v[64:67], v[124:127], v[52:55]
    v_mfma_f32_16x16x32_bf16 v[56:59], v[64:67], v[128:131], v[56:59]
    v_mfma_f32_16x16x32_bf16 v[60:63], v[64:67], v[132:135], v[60:63]
    s_add_u32 s31, s30, 5120
    buffer_load_dwordx4 a[112:115], v7, s[44:47], s31 offen offset:1024
    v_and_b32 v72, 15, v0
    v_lshlrev_b32 v13, 4, v72
    s_and_b32 s73, s56, 0xffffff00
    v_lshrrev_b32 v74, 5, v0
    s_lshl_b32 s66, s3, 1
    v_add_u32 v16, s66, v74
    v_mul_u32_u24 v16, 784, v16
    v_bfe_u32 v75, v0, 4, 1
    v_lshl_add_u32 v16, v75, 4, v16
    v_lshl_add_u32 v16, v72, 5, v16
    v_lshl_add_u32 v15, v74, 8, v16
    v_mul_u32_u24 v74, 768, v74
    v_sub_u32 v16, v16, v74
    v_add_u32 v16, 512, v16
    v_mul_u32_u24 v17, 784, v72
    v_lshrrev_b32 v73, 4, v0
    v_mul_u32_u24 v73, 24, v73
    s_mul_i32 s66, s3, 96
    v_add3_u32 v17, v17, v73, s66
    v_lshlrev_b32 v18, 5, v72
    v_lshl_add_u32 v18, v75, 4, v18
    s_mul_i32 s66, s3, 2576
    v_add_u32 v18, s66, v18
    v_and_b32 v68, v37, v3
    v_and_b32 v69, v37, v4
    v_and_b32 v70, v37, v5
    v_and_b32 v71, v37, v6
    s_waitcnt vmcnt(3)
    buffer_load_dwordx4 v[88:91], v2, s[36:39], s65 offen offset:0 nt
    s_waitcnt vmcnt(3)
    buffer_load_dwordx4 v[92:95], v2, s[36:39], s65 offen offset:256 nt
    s_waitcnt vmcnt(3)
    buffer_load_dwordx4 v[96:99], v2, s[36:39], s65 offen offset:512 nt
    s_add_u32 s65, s65, 3072
    s_cmp_eq_u32 s65, s15
    s_cselect_b32 s65, s14, s65
    s_nop 1
    v_mfma_f32_16x16x32_bf16 v[52:55], v[68:71], v[76:79], v[52:55]
    v_mfma_f32_16x16x32_bf16 v[56:59], v[68:71], v[80:83], v[56:59]
    v_mfma_f32_16x16x32_bf16 v[60:63], v[68:71], v[84:87], v[60:63]
    s_cmp_eq_u32 s101, 0
    s_cbranch_scc1 L_tl1
    s_lshl_b32 s72, s3, 12
    s_add_u32 s72, s72, 425984
    buffer_load_dwordx4 v[20:23], v19, s[48:51], s72 offen offset:0 sc1
    buffer_load_dwordx4 v[24:27], v19, s[48:51], s72 offen offset:1024 sc1
    buffer_load_dwordx4 v[28:31], v19, s[48:51], s72 offen offset:2048 sc1
    buffer_load_dwordx4 v[32:35], v19, s[48:51], s72 offen offset:3072 sc1
L_tl1:
    v_and_b32 v64, v38, v3
    v_and_b32 v65, v38, v4
    v_and_b32 v66, v38, v5
    v_and_b32 v67, v38, v6
    s_waitcnt vmcnt(2)
    buffer_load_dwordx4 v[100:103], v2, s[36:39], s65 offen offset:0 nt
    s_waitcnt vmcnt(2)
    buffer_load_dwordx4 v[104:107], v2, s[36:39], s65 offen offset:256 nt
    s_waitcnt vmcnt(2)
    buffer_load_dwordx4 v[108:111], v2, s[36:39], s65 offen offset:512 nt
    s_add_u32 s65, s65, 3072
    s_cmp_eq_u32 s65, s15
    s_cselect_b32 s65, s14, s65
    s_nop 1
    v_mfma_f32_16x16x32_bf16 v[52:55], v[64:67], v[88:91], v[52:55]
    v_mfma_f32_16x16x32_bf16 v[56:59], v[64:67], v[92:95], v[56:59]
    v_mfma_f32_16x16x32_bf16 v[60:63], v[64:67], v[96:99], v[60:63]
    s_add_u32 s31, s30, 20480
    buffer_load_dwordx4 a[116:119], v7, s[44:47], s31 offen offset:1024
    v_and_b32 v68, v39, v3
    v_and_b32 v69, v39, v4
    v_and_b32 v70, v39, v5
    v_and_b32 v71, v39, v6
    s_waitcnt vmcnt(3)
    buffer_load_dwordx4 v[112:115], v2, s[36:39], s65 offen offset:0 nt
    s_waitcnt vmcnt(3)
    buffer_load_dwordx4 v[116:119], v2, s[36:39], s65 offen offset:256 nt
    s_waitcnt vmcnt(3)
    buffer_load_dwordx4 v[120:123], v2, s[36:39], s65 offen offset:512 nt
    s_add_u32 s65, s65, 3072
    s_cmp_eq_u32 s65, s15
    s_cselect_b32 s65, s14, s65
    s_nop 1
    v_mfma_f32_16x16x32_bf16 v[52:55], v[68:71], v[100:103], v[52:55]
    v_mfma_f32_16x16x32_bf16 v[56:59], v[68:71], v[104:107], v[56:59]
    v_mfma_f32_16x16x32_bf16 v[60:63], v[68:71], v[108:111], v[60:63]
    v_and_b32 v64, v40, v3
    v_and_b32 v65, v40, v4
    v_and_b32 v66, v40, v5
    v_and_b32 v67, v40, v6
    s_waitcnt vmcnt(2)
    buffer_load_dwordx4 v[124:127], v2, s[36:39], s65 offen offset:0 nt
    s_waitcnt vmcnt(2)
    buffer_load_dwordx4 v[128:131], v2, s[36:39], s65 offen offset:256 nt
    s_waitcnt vmcnt(2)
    buffer_load_dwordx4 v[132:135], v2, s[36:39], s65 offen offset:512 nt
    s_add_u32 s65, s65, 3072
    s_cmp_eq_u32 s65, s15
    s_cselect_b32 s65, s14, s65
    s_nop 1
    v_mfma_f32_16x16x32_bf16 v[52:55], v[64:67], v[112:115], v[52:55]
    v_mfma_f32_16x16x32_bf16 v[56:59], v[64:67], v[116:119], v[56:59]
    v_mfma_f32_16x16x32_bf16 v[60:63], v[64:67], v[120:123], v[60:63]
    s_cmp_eq_u32 s101, 0
    s_cbranch_scc1 L_tl2
    s_and_b32 s68, s98, 0xffff
    s_lshr_b32 s69, s98, 16
    s_mov_b32 s74, 0
    s_branch L_tc_chk
L_tc_retry:
    buffer_load_dwordx4 v[20:23], v19, s[48:51], s72 offen offset:0 sc1
    buffer_load_dwordx4 v[24:27], v19, s[48:51], s72 offen offset:1024 sc1
    buffer_load_dwordx4 v[28:31], v19, s[48:51], s72 offen offset:2048 sc1
    buffer_load_dwordx4 v[32:35], v19, s[48:51], s72 offen offset:3072 sc1
    s_waitcnt vmcnt(0)
L_tc_chk:
    v_mov_b32 v72, 0
    v_xor_b32 v20, s68, v20
    v_xor_b32 v21, s69, v21
    v_or3_b32 v72, v72, v20, v21
    v_xor_b32 v22, s68, v22
    v_xor_b32 v23, s69, v23
    v_or3_b32 v72, v72, v22, v23
    v_xor_b32 v24, s68, v24
    v_xor_b32 v25, s69, v25
    v_or3_b32 v72, v72, v24, v25
    v_xor_b32 v26, s68, v26
    v_xor_b32 v27, s69, v27
    v_or3_b32 v72, v72, v26, v27
    v_xor_b32 v28, s68, v28
    v_xor_b32 v29, s69, v29
    v_or3_b32 v72, v72, v28, v29
    v_xor_b32 v30, s68, v30
    v_xor_b32 v31, s69, v31
    v_or3_b32 v72, v72, v30, v31
    v_xor_b32 v32, s68, v32
    v_xor_b32 v33, s69, v33
    v_or3_b32 v72, v72, v32, v33
    v_xor_b32 v34, s68, v34
    v_xor_b32 v35, s69, v35
    v_or3_b32 v72, v72, v34, v35
    v_and_b32 v72, 0xffff, v72
    v_cmp_ne_u32 vcc, 0, v72
    s_cbranch_vccz L_tc_ok
    s_add_u32 s74, s74, 1
    s_cmp_lt_u32 s74, 200000
    s_cbranch_scc1 L_tc_retry
L_tc_ok:
    v_lshrrev_b32 v72, 3, v0
    v_lshlrev_b32 v72, 5, v72
    v_sub_u32 v72, v19, v72
    s_mul_i32 s66, s3, 3072
    v_add_u32 v72, s66, v72
    s_mov_b32 exec_lo, 0x3f3f3f3f
    s_mov_b32 exec_hi, 0x3f3f3f3f
    ds_write_b128 v72, v[20:23] offset:57472
    ds_write_b128 v72, v[24:27] offset:58240
    ds_write_b128 v72, v[28:31] offset:59008
    ds_write_b128 v72, v[32:35] offset:59776
    s_mov_b64 exec, -1
    s_waitcnt lgkmcnt(0)
L_tl2:
    v_and_b32 v68, v41, v3
    v_and_b32 v69, v41, v4
    v_and_b32 v70, v41, v5
    v_and_b32 v71, v41, v6
    s_waitcnt vmcnt(2)
    buffer_load_dwordx4 v[76:79], v2, s[36:39], s65 offen offset:0 nt
    s_waitcnt vmcnt(2)
    buffer_load_dwordx4 v[80:83], v2, s[36:39], s65 offen offset:256 nt
    s_waitcnt vmcnt(2)
    buffer_load_dwordx4 v[84:87], v2, s[36:39], s65 offen offset:512 nt
    s_add_u32 s65, s65, 3072
    s_cmp_eq_u32 s65, s15
    s_cselect_b32 s65, s14, s65
    s_nop 1
    v_mfma_f32_16x16x32_bf16 v[52:55], v[68:71], v[124:127], v[52:55]
    v_mfma_f32_16x16x32_bf16 v[56:59], v[68:71], v[128:131], v[56:59]
    v_mfma_f32_16x16x32_bf16 v[60:63], v[68:71], v[132:135], v[60:63]
    v_and_b32 v64, v42, v3
    v_and_b32 v65, v42, v4
    v_and_b32 v66, v42, v5
    v_and_b32 v67, v42, v6
    s_waitcnt vmcnt(2)
    buffer_load_dwordx4 v[88:91], v2, s[36:39], s65 offen offset:0 nt
    s_waitcnt vmcnt(2)
    buffer_load_dwordx4 v[92:95], v2, s[36:39], s65 offen offset:256 nt
    s_waitcnt vmcnt(2)
    buffer_load_dwordx4 v[96:99], v2, s[36:39], s65 offen offset:512 nt
    s_add_u32 s65, s65, 3072
    s_cmp_eq_u32 s65, s15
    s_cselect_b32 s65, s14, s65
    s_nop 1
    v_mfma_f32_16x16x32_bf16 v[52:55], v[64:67], v[76:79], v[52:55]
    v_mfma_f32_16x16x32_bf16 v[56:59], v[64:67], v[80:83], v[56:59]
    v_mfma_f32_16x16x32_bf16 v[60:63], v[64:67], v[84:87], v[60:63]
    v_and_b32 v68, v43, v3
    v_and_b32 v69, v43, v4
    v_and_b32 v70, v43, v5
    v_and_b32 v71, v43, v6
    s_waitcnt vmcnt(2)
    buffer_load_dwordx4 v[100:103], v2, s[36:39], s65 offen offset:0 nt
    s_waitcnt vmcnt(2)
    buffer_load_dwordx4 v[104:107], v2, s[36:39], s65 offen offset:256 nt
    s_waitcnt vmcnt(2)
    buffer_load_dwordx4 v[108:111], v2, s[36:39], s65 offen offset:512 nt
    s_add_u32 s65, s65, 3072
    s_cmp_eq_u32 s65, s15
    s_cselect_b32 s65, s14, s65
    s_nop 1
    v_mfma_f32_16x16x32_bf16 v[52:55], v[68:71], v[88:91], v[52:55]
    v_mfma_f32_16x16x32_bf16 v[56:59], v[68:71], v[92:95], v[56:59]
    v_mfma_f32_16x16x32_bf16 v[60:63], v[68:71], v[96:99], v[60:63]
    buffer_load_dwordx4 v[8:11], v13, s[48:51], s73 offen sc1
    v_and_b32 v64, v44, v3
    v_and_b32 v65, v44, v4
    v_and_b32 v66, v44, v5
    v_and_b32 v67, v44, v6
    s_waitcnt vmcnt(3)
    buffer_load_dwordx4 v[112:115], v2, s[36:39], s65 offen offset:0 nt
    s_waitcnt vmcnt(3)
    buffer_load_dwordx4 v[116:119], v2, s[36:39], s65 offen offset:256 nt
    s_waitcnt vmcnt(3)
    buffer_load_dwordx4 v[120:123], v2, s[36:39], s65 offen offset:512 nt
    s_add_u32 s65, s65, 3072
    s_cmp_eq_u32 s65, s15
    s_cselect_b32 s65, s14, s65
    s_nop 1
    v_mfma_f32_16x16x32_bf16 v[52:55], v[64:67], v[100:103], v[52:55]
    v_mfma_f32_16x16x32_bf16 v[56:59], v[64:67], v[104:107], v[56:59]
    v_mfma_f32_16x16x32_bf16 v[60:63], v[64:67], v[108:111], v[60:63]
    v_and_b32 v68, v45, v3
    v_and_b32 v69, v45, v4
    v_and_b32 v70, v45, v5
    v_and_b32 v71, v45, v6
    s_waitcnt vmcnt(2)
    buffer_load_dwordx4 v[124:127], v2, s[36:39], s65 offen offset:0 nt
    s_waitcnt vmcnt(2)
    buffer_load_dwordx4 v[128:131], v2, s[36:39], s65 offen offset:256 nt
    buffer_load_dwordx4 v[132:135], v2, s[36:39], s65 offen offset:512 nt
    s_add_u32 s65, s65, 3072
    s_cmp_eq_u32 s65, s15
    s_cselect_b32 s65, s14, s65
    s_waitcnt vmcnt(3)
    buffer_load_dwordx4 v[76:79], v2, s[36:39], s65 offen offset:0 nt
    s_nop 1
    v_mfma_f32_16x16x32_bf16 v[52:55], v[68:71], v[112:115], v[52:55]
    v_mfma_f32_16x16x32_bf16 v[56:59], v[68:71], v[116:119], v[56:59]
    v_mfma_f32_16x16x32_bf16 v[60:63], v[68:71], v[120:123], v[60:63]
    v_and_b32 v64, v46, v3
    v_and_b32 v65, v46, v4
    v_and_b32 v66, v46, v5
    v_and_b32 v67, v46, v6
    s_waitcnt vmcnt(3)
    buffer_load_dwordx4 v[80:83], v2, s[36:39], s65 offen offset:256 nt
    s_waitcnt vmcnt(3)
    buffer_load_dwordx4 v[84:87], v2, s[36:39], s65 offen offset:512 nt
    s_add_u32 s65, s65, 3072
    s_cmp_eq_u32 s65, s15
    s_cselect_b32 s65, s14, s65
    s_waitcnt vmcnt(3)
    buffer_load_dwordx4 v[88:91], v2, s[36:39], s65 offen offset:0 nt
    s_nop 1
    v_mfma_f32_16x16x32_bf16 v[52:55], v[64:67], v[124:127], v[52:55]
    v_mfma_f32_16x16x32_bf16 v[56:59], v[64:67], v[128:131], v[56:59]
    v_mfma_f32_16x16x32_bf16 v[60:63], v[64:67], v[132:135], v[60:63]
    v_and_b32 v68, v47, v3
    v_and_b32 v69, v47, v4
    v_and_b32 v70, v47, v5
    v_and_b32 v71, v47, v6
    s_waitcnt vmcnt(3)
    buffer_load_dwordx4 v[92:95], v2, s[36:39], s65 offen offset:256 nt
    s_waitcnt vmcnt(3)
    buffer_load_dwordx4 v[96:99], v2, s[36:39], s65 offen offset:512 nt
    s_add_u32 s65, s65, 3072
    s_cmp_eq_u32 s65, s15
    s_cselect_b32 s65, s14, s65
    s_waitcnt vmcnt(3)
    buffer_load_dwordx4 v[100:103], v2, s[36:39], s65 offen offset:0 nt
    s_nop 1
    v_mfma_f32_16x16x32_bf16 v[52:55], v[68:71], v[76:79], v[52:55]
    v_mfma_f32_16x16x32_bf16 v[56:59], v[68:71], v[80:83], v[56:59]
    v_mfma_f32_16x16x32_bf16 v[60:63], v[68:71], v[84:87], v[60:63]
    v_and_b32 v64, v48, v3
    v_and_b32 v65, v48, v4
    v_and_b32 v66, v48, v5
    v_and_b32 v67, v48, v6
    s_waitcnt vmcnt(3)
    buffer_load_dwordx4 v[104:107], v2, s[36:39], s65 offen offset:256 nt
    s_waitcnt vmcnt(3)
    buffer_load_dwordx4 v[108:111], v2, s[36:39], s65 offen offset:512 nt
    s_add_u32 s65, s65, 3072
    s_cmp_eq_u32 s65, s15
    s_cselect_b32 s65, s14, s65
    s_waitcnt vmcnt(3)
    buffer_load_dwordx4 v[112:115], v2, s[36:39], s65 offen offset:0 nt
    buffer_load_dwordx4 v[116:119], v2, s[36:39], s65 offen offset:256 nt
    buffer_load_dwordx4 v[120:123], v2, s[36:39], s65 offen offset:512 nt
    s_add_u32 s65, s65, 3072
    s_cmp_eq_u32 s65, s15
    s_cselect_b32 s65, s14, s65
    buffer_load_dwordx4 v[124:127], v2, s[36:39], s65 offen offset:0 nt
    buffer_load_dwordx4 v[128:131], v2, s[36:39], s65 offen offset:256 nt
    s_nop 1
    v_mfma_f32_16x16x32_bf16 v[52:55], v[64:67], v[88:91], v[52:55]
    v_mfma_f32_16x16x32_bf16 v[56:59], v[64:67], v[92:95], v[56:59]
    v_mfma_f32_16x16x32_bf16 v[60:63], v[64:67], v[96:99], v[60:63]
    s_mov_b32 s66, 0x0f0f0f0f
    s_mov_b32 s67, 0x0f0f0f0f
    v_mov_b32 v72, 0xffff
    v_mov_b32 v73, 0xffff0000
    v_cndmask_b32 v20, 0, v72, s[66:67]
    v_cndmask_b32 v21, v72, 0, s[66:67]
    v_cndmask_b32 v22, 0, v73, s[66:67]
    v_cndmask_b32 v23, v73, 0, s[66:67]
    v_and_b32 v24, 3, v0
    v_mul_u32_u24 v24, 0x5555, v24
    s_lshl_b32 s66, s3, 10
    v_add_u32 v25, s66, v19
    v_lshrrev_b32 v26, 1, v25
    v_lshlrev_b32 v27, 2, v0
    s_lshl_b32 s76, s61, 6
    s_add_u32 s76, s76, s3
    s_mul_i32 s76, s76, 1280
    v_mov_b32 v28, 0
    v_mov_b32 v29, 0
    v_mov_b32 v30, 0
    v_mov_b32 v31, 0
    v_mov_b32 v32, 0
    v_mov_b32 v33, 0
    v_mov_b32 v34, 0
    v_mov_b32 v35, 0
    v_mov_b32 v36, 0
    v_mov_b32 v37, 0
    v_mov_b32 v38, 0
    v_mov_b32 v39, 0
    v_mov_b32 v40, 0
    v_mov_b32 v41, 0
    v_mov_b32 v42, 0
    v_mov_b32 v43, 0
    v_mov_b32 v44, 0
    v_mov_b32 v45, 0
    v_mov_b32 v46, 0
    v_mov_b32 v47, 0
    v_and_b32 v68, v49, v3
    v_and_b32 v69, v49, v4
    v_and_b32 v70, v49, v5
    v_and_b32 v71, v49, v6
    s_waitcnt vmcnt(7)
    buffer_load_dwordx4 v[132:135], v2, s[36:39], s65 offen offset:512 nt
    s_waitcnt vmcnt(7)
    s_waitcnt vmcnt(6)
    s_nop 1
    v_mfma_f32_16x16x32_bf16 v[52:55], v[68:71], v[100:103], v[52:55]
    v_mfma_f32_16x16x32_bf16 v[56:59], v[68:71], v[104:107], v[56:59]
    v_mfma_f32_16x16x32_bf16 v[60:63], v[68:71], v[108:111], v[60:63]
    s_mov_b32 s74, 0
    s_branch L_ml_chk
L_ml_retry:
    buffer_load_dwordx4 v[8:11], v13, s[48:51], s73 offen sc1
    s_waitcnt vmcnt(0)
L_ml_chk:
    v_xor_b32 v72, s98, v9
    v_xor_b32 v73, s99, v11
    v_or_b32 v72, v72, v73
    v_cmp_ne_u32 vcc, 0, v72
    s_cbranch_vccz L_ml_ok
    s_add_u32 s74, s74, 1
    s_cmp_lt_u32 s74, 200000
    s_cbranch_scc1 L_ml_retry
L_ml_ok:
    v_mov_b32 v72, v8
    s_nop 1
    v_max_f32_dpp v72, v72, v72 quad_perm:[1,0,3,2] row_mask:0xf bank_mask:0xf
    s_nop 1
    v_max_f32_dpp v72, v72, v72 quad_perm:[2,3,0,1] row_mask:0xf bank_mask:0xf
    s_nop 1
    v_max_f32_dpp v72, v72, v72 row_half_mirror row_mask:0xf bank_mask:0xf
    s_nop 1
    v_max_f32_dpp v72, v72, v72 row_mirror row_mask:0xf bank_mask:0xf
    v_sub_f32 v73, v8, v72
    v_sub_f32 v74, s58, v72
    v_exp_f32 v73, v73
    v_exp_f32 v74, v74
    v_mul_f32 v73, v73, v10
    s_nop 1
    v_add_f32_dpp v73, v73, v73 quad_perm:[1,0,3,2] row_mask:0xf bank_mask:0xf
    s_nop 1
    v_add_f32_dpp v73, v73, v73 quad_perm:[2,3,0,1] row_mask:0xf bank_mask:0xf
    s_nop 1
    v_add_f32_dpp v73, v73, v73 row_half_mirror row_mask:0xf bank_mask:0xf
    s_nop 1
    v_add_f32_dpp v73, v73, v73 row_mirror row_mask:0xf bank_mask:0xf
    v_rcp_f32 v73, v73
    s_nop 0
    v_mul_f32 v14, v73, v74
    v_mul_f32 v52, v14, v52
    v_mul_f32 v53, v14, v53
    v_mul_f32 v54, v14, v54
    v_mul_f32 v55, v14, v55
    v_mul_f32 v56, v14, v56
    v_mul_f32 v57, v14, v57
    v_mul_f32 v58, v14, v58
    v_mul_f32 v59, v14, v59
    v_mul_f32 v60, v14, v60
    v_mul_f32 v61, v14, v61
    v_mul_f32 v62, v14, v62
    v_mul_f32 v63, v14, v63
    v_mul_f32 v50, v14, v50
    v_cvt_pk_bf16_f32 v50, v50, v50
    v_mul_f32 v51, v14, v51
    v_cvt_pk_bf16_f32 v51, v51, v51
    v_and_b32 v64, v50, v3
    v_and_b32 v65, v50, v4
    v_and_b32 v66, v50, v5
    v_and_b32 v67, v50, v6
    s_waitcnt vmcnt(5)
    s_waitcnt vmcnt(4)
    s_waitcnt vmcnt(3)
    s_nop 1
    v_mfma_f32_16x16x32_bf16 v[52:55], v[64:67], v[112:115], v[52:55]
    v_mfma_f32_16x16x32_bf16 v[56:59], v[64:67], v[116:119], v[56:59]
    v_mfma_f32_16x16x32_bf16 v[60:63], v[64:67], v[120:123], v[60:63]
    v_and_b32 v68, v51, v3
    v_and_b32 v69, v51, v4
    v_and_b32 v70, v51, v5
    v_and_b32 v71, v51, v6
    s_waitcnt vmcnt(2)
    s_waitcnt vmcnt(1)
    s_waitcnt vmcnt(0)
    s_nop 1
    v_mfma_f32_16x16x32_bf16 v[52:55], v[68:71], v[124:127], v[52:55]
    v_mfma_f32_16x16x32_bf16 v[56:59], v[68:71], v[128:131], v[56:59]
    v_mfma_f32_16x16x32_bf16 v[60:63], v[68:71], v[132:135], v[60:63]
    s_nop 4
    s_mov_b32 exec_hi, 0
    ds_write_b128 v15, v[52:55] offset:0
    s_mov_b32 exec_lo, 0x00ff00ff
    s_mov_b32 exec_hi, 0xff00ff00
    ds_write_b128 v16, v[56:59] offset:0
    s_mov_b32 exec_lo, 0
    s_mov_b32 exec_hi, -1
    ds_write_b128 v15, v[60:63] offset:0
    s_mov_b64 exec, -1
    s_cmp_eq_u32 s101, 0
    s_waitcnt lgkmcnt(0)
    s_barrier
    ds_read_b64 v[76:77], v17 offset:0
    ds_read_b64 v[78:79], v17 offset:8
    ds_read_b64 v[80:81], v17 offset:16
    s_cbranch_scc1 L_nor1
    s_add_u32 s68, s76, 0
    buffer_load_dwordx4 v[84:87], v19, s[48:51], s68 offen sc1
    buffer_load_dword v88, v27, s[48:51], s68 offen offset:1024 sc1
    s_add_u32 s68, s76, 10240
    buffer_load_dwordx4 v[90:93], v19, s[48:51], s68 offen sc1
    buffer_load_dword v94, v27, s[48:51], s68 offen offset:1024 sc1
    s_add_u32 s68, s76, 20480
    buffer_load_dwordx4 v[96:99], v19, s[48:51], s68 offen sc1
    buffer_load_dword v100, v27, s[48:51], s68 offen offset:1024 sc1
    s_add_u32 s68, s76, 30720
    buffer_load_dwordx4 v[102:105], v19, s[48:51], s68 offen sc1
    buffer_load_dword v106, v27, s[48:51], s68 offen offset:1024 sc1
    s_add_u32 s68, s76, 40960
    buffer_load_dwordx4 v[108:111], v19, s[48:51], s68 offen sc1
    buffer_load_dword v112, v27, s[48:51], s68 offen offset:1024 sc1
    s_add_u32 s68, s76, 51200
    buffer_load_dwordx4 v[114:117], v19, s[48:51], s68 offen sc1
    buffer_load_dword v118, v27, s[48:51], s68 offen offset:1024 sc1
    s_add_u32 s68, s76, 61440
    buffer_load_dwordx4 v[120:123], v19, s[48:51], s68 offen sc1
    buffer_load_dword v124, v27, s[48:51], s68 offen offset:1024 sc1
    s_add_u32 s68, s76, 71680
    buffer_load_dwordx4 v[126:129], v19, s[48:51], s68 offen sc1
    buffer_load_dword v130, v27, s[48:51], s68 offen offset:1024 sc1
L_nor1:
    s_waitcnt lgkmcnt(0)
    v_add_f32_dpp v76, v76, v76 quad_perm:[1,0,3,2] row_mask:0xf bank_mask:0xf
    v_add_f32_dpp v77, v77, v77 quad_perm:[1,0,3,2] row_mask:0xf bank_mask:0xf
    v_add_f32_dpp v78, v78, v78 quad_perm:[1,0,3,2] row_mask:0xf bank_mask:0xf
    v_add_f32_dpp v76, v76, v76 quad_perm:[2,3,0,1] row_mask:0xf bank_mask:0xf
    v_add_f32_dpp v77, v77, v77 quad_perm:[2,3,0,1] row_mask:0xf bank_mask:0xf
    v_add_f32_dpp v78, v78, v78 quad_perm:[2,3,0,1] row_mask:0xf bank_mask:0xf
    v_add_f32_dpp v76, v76, v76 row_half_mirror row_mask:0xf bank_mask:0xf
    v_add_f32_dpp v77, v77, v77 row_half_mirror row_mask:0xf bank_mask:0xf
    v_add_f32_dpp v78, v78, v78 row_half_mirror row_mask:0xf bank_mask:0xf
    v_add_f32_dpp v76, v76, v76 row_mirror row_mask:0xf bank_mask:0xf
    v_add_f32_dpp v77, v77, v77 row_mirror row_mask:0xf bank_mask:0xf
    v_add_f32_dpp v78, v78, v78 row_mirror row_mask:0xf bank_mask:0xf
    v_cvt_pk_bf16_f32 v76, v76, v77
    v_and_b32 v64, v76, v20
    v_and_b32 v65, v76, v21
    v_and_b32 v66, v76, v22
    v_and_b32 v67, v76, v23
    v_add_f32_dpp v79, v79, v79 quad_perm:[1,0,3,2] row_mask:0xf bank_mask:0xf
    v_add_f32_dpp v80, v80, v80 quad_perm:[1,0,3,2] row_mask:0xf bank_mask:0xf
    v_smfmac_f32_16x16x64_bf16 v[28:31], v[64:67], a[0:7], v24
    v_add_f32_dpp v81, v81, v81 quad_perm:[1,0,3,2] row_mask:0xf bank_mask:0xf
    v_add_f32_dpp v79, v79, v79 quad_perm:[2,3,0,1] row_mask:0xf bank_mask:0xf
    v_add_f32_dpp v80, v80, v80 quad_perm:[2,3,0,1] row_mask:0xf bank_mask:0xf
    v_smfmac_f32_16x16x64_bf16 v[32:35], v[64:67], a[8:15], v24
    v_add_f32_dpp v81, v81, v81 quad_perm:[2,3,0,1] row_mask:0xf bank_mask:0xf
    v_add_f32_dpp v79, v79, v79 row_half_mirror row_mask:0xf bank_mask:0xf
    v_add_f32_dpp v80, v80, v80 row_half_mirror row_mask:0xf bank_mask:0xf
    v_smfmac_f32_16x16x64_bf16 v[36:39], v[64:67], a[16:23], v24
    v_add_f32_dpp v81, v81, v81 row_half_mirror row_mask:0xf bank_mask:0xf
    v_add_f32_dpp v79, v79, v79 row_mirror row_mask:0xf bank_mask:0xf
    v_add_f32_dpp v80, v80, v80 row_mirror row_mask:0xf bank_mask:0xf
    v_smfmac_f32_16x16x64_bf16 v[40:43], v[64:67], a[24:31], v24
    v_add_f32_dpp v81, v81, v81 row_mirror row_mask:0xf bank_mask:0xf
    v_cvt_pk_bf16_f32 v78, v78, v79
    v_and_b32 v68, v78, v20
    v_smfmac_f32_16x16x64_bf16 v[44:47], v[64:67], a[32:39], v24
    v_and_b32 v69, v78, v21
    v_and_b32 v70, v78, v22
    v_and_b32 v71, v78, v23
    s_nop 1
    v_smfmac_f32_16x16x64_bf16 v[28:31], v[68:71], a[40:47], v24
    v_cvt_pk_bf16_f32 v80, v80, v81
    v_and_b32 v52, v80, v20
    v_smfmac_f32_16x16x64_bf16 v[32:35], v[68:71], a[48:55], v24
    v_and_b32 v53, v80, v21
    v_and_b32 v54, v80, v22
    v_smfmac_f32_16x16x64_bf16 v[36:39], v[68:71], a[56:63], v24
    v_and_b32 v55, v80, v23
    v_smfmac_f32_16x16x64_bf16 v[40:43], v[68:71], a[64:71], v24
    v_smfmac_f32_16x16x64_bf16 v[44:47], v[68:71], a[72:79], v24
    v_smfmac_f32_16x16x64_bf16 v[28:31], v[52:55], a[80:87], v24
    v_smfmac_f32_16x16x64_bf16 v[32:35], v[52:55], a[88:95], v24
    v_smfmac_f32_16x16x64_bf16 v[36:39], v[52:55], a[96:103], v24
    v_smfmac_f32_16x16x64_bf16 v[40:43], v[52:55], a[104:111], v24
    v_smfmac_f32_16x16x64_bf16 v[44:47], v[52:55], a[112:119], v24
    s_mov_b32 exec_hi, 0
    s_cmp_lg_u32 s101, 0
    s_nop 1
    ds_write_b128 v18, v[28:31] offset:16384
    ds_write_b128 v18, v[32:35] offset:16896
    ds_write_b128 v18, v[36:39] offset:17408
    ds_write_b128 v18, v[40:43] offset:17920
    ds_write_b128 v18, v[44:47] offset:18432
    s_mov_b64 exec, -1
    s_cbranch_scc1 L_reducer
    s_cmp_ge_u32 s3, 3
    s_waitcnt lgkmcnt(0)
    s_barrier
    s_cbranch_scc1 L_end
    s_cmp_lg_u32 s3, 2
    s_cselect_b32 exec_hi, -1, 0
    ds_read_b128 v[76:79], v25 offset:16384
    ds_read_b128 v[80:83], v25 offset:18960
    ds_read_b128 v[84:87], v25 offset:21536
    ds_read_b128 v[88:91], v25 offset:24112
    ds_read_b128 v[92:95], v25 offset:26688
    ds_read_b128 v[96:99], v25 offset:29264
    ds_read_b128 v[100:103], v25 offset:31840
    ds_read_b128 v[104:107], v25 offset:34416
    s_waitcnt lgkmcnt(0)
    v_pk_add_f32 v[76:77], v[76:77], v[92:93]
    v_pk_add_f32 v[78:79], v[78:79], v[94:95]
    v_pk_add_f32 v[80:81], v[80:81], v[96:97]
    v_pk_add_f32 v[82:83], v[82:83], v[98:99]
    v_pk_add_f32 v[84:85], v[84:85], v[100:101]
    v_pk_add_f32 v[86:87], v[86:87], v[102:103]
    v_pk_add_f32 v[88:89], v[88:89], v[104:105]
    v_pk_add_f32 v[90:91], v[90:91], v[106:107]
    v_pk_add_f32 v[76:77], v[76:77], v[84:85]
    v_pk_add_f32 v[78:79], v[78:79], v[86:87]
    v_pk_add_f32 v[80:81], v[80:81], v[88:89]
    v_pk_add_f32 v[82:83], v[82:83], v[90:91]
    v_pk_add_f32 v[76:77], v[76:77], v[80:81]
    v_pk_add_f32 v[78:79], v[78:79], v[82:83]
    v_cvt_pk_bf16_f32 v76, v76, v77
    v_cvt_pk_bf16_f32 v77, v78, v79
    v_min_u32 v76, -2, v76
    v_min_u32 v77, -2, v77
    buffer_store_dwordx2 v[76:77], v26, s[48:51], s57 offen sc1
    s_endpgm
L_reducer:
    s_mul_i32 s66, s3, 2576
    v_lshl_add_u32 v65, v0, 5, s66
    v_lshl_add_u32 v66, v0, 3, s66
    s_waitcnt lgkmcnt(0)
    ds_read_b128 v[52:55], v65 offset:16384
    ds_read_b128 v[56:59], v65 offset:16400
    ds_read_b64 v[60:61], v66 offset:18432
    s_min_u32 s68, s3, 4
    s_lshl_b32 s68, s68, 8
    v_add_u32 v78, s68, v27
    v_lshlrev_b32 v67, 1, v78
    s_mul_i32 s67, s61, 1280
    v_add_u32 v78, s67, v78
    buffer_load_dword v79, v78, s[52:55], 0 offen
    s_mul_i32 s66, s3, 2560
    v_lshl_add_u32 v65, v0, 5, s66
    v_lshl_add_u32 v66, v0, 3, s66
    s_lshl_b32 s67, s3, 3
    v_mov_b32 v68, s67
    v_mov_b32 v69, 3071
    v_mov_b32 v74, 3072
    v_mov_b32 v75, 3071
    v_mov_b32 v76, 0x3f80
    v_mov_b32 v77, 0x3f800000
    s_mov_b32 s73, 0xff
    s_lshr_b32 s66, s63, 3
    s_and_b32 s67, s63, 7
    s_cmp_eq_u32 s67, s3
    s_cselect_b32 s66, s66, 8
    s_bitset0_b32 s73, s66
    s_mov_b32 s74, 0
    s_waitcnt vmcnt(0) lgkmcnt(0)
    v_lshlrev_b32 v70, 16, v79
    v_and_b32 v71, 0xffff0000, v79
    s_branch L_rp_chk
L_rp_retry:
    s_bitcmp1_b32 s73, 0
    s_cbranch_scc0 L_rp_i0
    s_add_u32 s68, s76, 0
    buffer_load_dwordx4 v[84:87], v19, s[48:51], s68 offen sc1
    buffer_load_dword v88, v27, s[48:51], s68 offen offset:1024 sc1
L_rp_i0:
    s_bitcmp1_b32 s73, 1
    s_cbranch_scc0 L_rp_i1
    s_add_u32 s68, s76, 10240
    buffer_load_dwordx4 v[90:93], v19, s[48:51], s68 offen sc1
    buffer_load_dword v94, v27, s[48:51], s68 offen offset:1024 sc1
L_rp_i1:
    s_bitcmp1_b32 s73, 2
    s_cbranch_scc0 L_rp_i2
    s_add_u32 s68, s76, 20480
    buffer_load_dwordx4 v[96:99], v19, s[48:51], s68 offen sc1
    buffer_load_dword v100, v27, s[48:51], s68 offen offset:1024 sc1
L_rp_i2:
    s_bitcmp1_b32 s73, 3
    s_cbranch_scc0 L_rp_i3
    s_add_u32 s68, s76, 30720
    buffer_load_dwordx4 v[102:105], v19, s[48:51], s68 offen sc1
    buffer_load_dword v106, v27, s[48:51], s68 offen offset:1024 sc1
L_rp_i3:
    s_bitcmp1_b32 s73, 4
    s_cbranch_scc0 L_rp_i4
    s_add_u32 s68, s76, 40960
    buffer_load_dwordx4 v[108:111], v19, s[48:51], s68 offen sc1
    buffer_load_dword v112, v27, s[48:51], s68 offen offset:1024 sc1
L_rp_i4:
    s_bitcmp1_b32 s73, 5
    s_cbranch_scc0 L_rp_i5
    s_add_u32 s68, s76, 51200
    buffer_load_dwordx4 v[114:117], v19, s[48:51], s68 offen sc1
    buffer_load_dword v118, v27, s[48:51], s68 offen offset:1024 sc1
L_rp_i5:
    s_bitcmp1_b32 s73, 6
    s_cbranch_scc0 L_rp_i6
    s_add_u32 s68, s76, 61440
    buffer_load_dwordx4 v[120:123], v19, s[48:51], s68 offen sc1
    buffer_load_dword v124, v27, s[48:51], s68 offen offset:1024 sc1
L_rp_i6:
    s_bitcmp1_b32 s73, 7
    s_cbranch_scc0 L_rp_i7
    s_add_u32 s68, s76, 71680
    buffer_load_dwordx4 v[126:129], v19, s[48:51], s68 offen sc1
    buffer_load_dword v130, v27, s[48:51], s68 offen offset:1024 sc1
L_rp_i7:
    s_waitcnt vmcnt(0)
L_rp_chk:
    s_bitcmp1_b32 s73, 0
    s_cbranch_scc0 L_rp_c0
    v_max3_u32 v64, v84, v85, v86
    v_max3_u32 v64, v64, v87, v88
    v_cmp_eq_u32 vcc, -1, v64
    s_cbranch_vccnz L_rp_c0
    s_bitset0_b32 s73, 0
    v_dot2c_f32_bf16 v52, v84, v76
    v_dot2c_f32_bf16 v53, v84, v77
    v_dot2c_f32_bf16 v54, v85, v76
    v_dot2c_f32_bf16 v55, v85, v77
    v_dot2c_f32_bf16 v56, v86, v76
    v_dot2c_f32_bf16 v57, v86, v77
    v_dot2c_f32_bf16 v58, v87, v76
    v_dot2c_f32_bf16 v59, v87, v77
    v_dot2c_f32_bf16 v60, v88, v76
    v_dot2c_f32_bf16 v61, v88, v77
L_rp_c0:
    s_bitcmp1_b32 s73, 1
    s_cbranch_scc0 L_rp_c1
    v_max3_u32 v64, v90, v91, v92
    v_max3_u32 v64, v64, v93, v94
    v_cmp_eq_u32 vcc, -1, v64
    s_cbranch_vccnz L_rp_c1
    s_bitset0_b32 s73, 1
    v_dot2c_f32_bf16 v52, v90, v76
    v_dot2c_f32_bf16 v53, v90, v77
    v_dot2c_f32_bf16 v54, v91, v76
    v_dot2c_f32_bf16 v55, v91, v77
    v_dot2c_f32_bf16 v56, v92, v76
    v_dot2c_f32_bf16 v57, v92, v77
    v_dot2c_f32_bf16 v58, v93, v76
    v_dot2c_f32_bf16 v59, v93, v77
    v_dot2c_f32_bf16 v60, v94, v76
    v_dot2c_f32_bf16 v61, v94, v77
L_rp_c1:
    s_bitcmp1_b32 s73, 2
    s_cbranch_scc0 L_rp_c2
    v_max3_u32 v64, v96, v97, v98
    v_max3_u32 v64, v64, v99, v100
    v_cmp_eq_u32 vcc, -1, v64
    s_cbranch_vccnz L_rp_c2
    s_bitset0_b32 s73, 2
    v_dot2c_f32_bf16 v52, v96, v76
    v_dot2c_f32_bf16 v53, v96, v77
    v_dot2c_f32_bf16 v54, v97, v76
    v_dot2c_f32_bf16 v55, v97, v77
    v_dot2c_f32_bf16 v56, v98, v76
    v_dot2c_f32_bf16 v57, v98, v77
    v_dot2c_f32_bf16 v58, v99, v76
    v_dot2c_f32_bf16 v59, v99, v77
    v_dot2c_f32_bf16 v60, v100, v76
    v_dot2c_f32_bf16 v61, v100, v77
L_rp_c2:
    s_bitcmp1_b32 s73, 3
    s_cbranch_scc0 L_rp_c3
    v_max3_u32 v64, v102, v103, v104
    v_max3_u32 v64, v64, v105, v106
    v_cmp_eq_u32 vcc, -1, v64
    s_cbranch_vccnz L_rp_c3
    s_bitset0_b32 s73, 3
    v_dot2c_f32_bf16 v52, v102, v76
    v_dot2c_f32_bf16 v53, v102, v77
    v_dot2c_f32_bf16 v54, v103, v76
    v_dot2c_f32_bf16 v55, v103, v77
    v_dot2c_f32_bf16 v56, v104, v76
    v_dot2c_f32_bf16 v57, v104, v77
    v_dot2c_f32_bf16 v58, v105, v76
    v_dot2c_f32_bf16 v59, v105, v77
    v_dot2c_f32_bf16 v60, v106, v76
    v_dot2c_f32_bf16 v61, v106, v77
L_rp_c3:
    s_bitcmp1_b32 s73, 4
    s_cbranch_scc0 L_rp_c4
    v_max3_u32 v64, v108, v109, v110
    v_max3_u32 v64, v64, v111, v112
    v_cmp_eq_u32 vcc, -1, v64
    s_cbranch_vccnz L_rp_c4
    s_bitset0_b32 s73, 4
    v_dot2c_f32_bf16 v52, v108, v76
    v_dot2c_f32_bf16 v53, v108, v77
    v_dot2c_f32_bf16 v54, v109, v76
    v_dot2c_f32_bf16 v55, v109, v77
    v_dot2c_f32_bf16 v56, v110, v76
    v_dot2c_f32_bf16 v57, v110, v77
    v_dot2c_f32_bf16 v58, v111, v76
    v_dot2c_f32_bf16 v59, v111, v77
    v_dot2c_f32_bf16 v60, v112, v76
    v_dot2c_f32_bf16 v61, v112, v77
L_rp_c4:
    s_bitcmp1_b32 s73, 5
    s_cbranch_scc0 L_rp_c5
    v_max3_u32 v64, v114, v115, v116
    v_max3_u32 v64, v64, v117, v118
    v_cmp_eq_u32 vcc, -1, v64
    s_cbranch_vccnz L_rp_c5
    s_bitset0_b32 s73, 5
    v_dot2c_f32_bf16 v52, v114, v76
    v_dot2c_f32_bf16 v53, v114, v77
    v_dot2c_f32_bf16 v54, v115, v76
    v_dot2c_f32_bf16 v55, v115, v77
    v_dot2c_f32_bf16 v56, v116, v76
    v_dot2c_f32_bf16 v57, v116, v77
    v_dot2c_f32_bf16 v58, v117, v76
    v_dot2c_f32_bf16 v59, v117, v77
    v_dot2c_f32_bf16 v60, v118, v76
    v_dot2c_f32_bf16 v61, v118, v77
L_rp_c5:
    s_bitcmp1_b32 s73, 6
    s_cbranch_scc0 L_rp_c6
    v_max3_u32 v64, v120, v121, v122
    v_max3_u32 v64, v64, v123, v124
    v_cmp_eq_u32 vcc, -1, v64
    s_cbranch_vccnz L_rp_c6
    s_bitset0_b32 s73, 6
    v_dot2c_f32_bf16 v52, v120, v76
    v_dot2c_f32_bf16 v53, v120, v77
    v_dot2c_f32_bf16 v54, v121, v76
    v_dot2c_f32_bf16 v55, v121, v77
    v_dot2c_f32_bf16 v56, v122, v76
    v_dot2c_f32_bf16 v57, v122, v77
    v_dot2c_f32_bf16 v58, v123, v76
    v_dot2c_f32_bf16 v59, v123, v77
    v_dot2c_f32_bf16 v60, v124, v76
    v_dot2c_f32_bf16 v61, v124, v77
L_rp_c6:
    s_bitcmp1_b32 s73, 7
    s_cbranch_scc0 L_rp_c7
    v_max3_u32 v64, v126, v127, v128
    v_max3_u32 v64, v64, v129, v130
    v_cmp_eq_u32 vcc, -1, v64
    s_cbranch_vccnz L_rp_c7
    s_bitset0_b32 s73, 7
    v_dot2c_f32_bf16 v52, v126, v76
    v_dot2c_f32_bf16 v53, v126, v77
    v_dot2c_f32_bf16 v54, v127, v76
    v_dot2c_f32_bf16 v55, v127, v77
    v_dot2c_f32_bf16 v56, v128, v76
    v_dot2c_f32_bf16 v57, v128, v77
    v_dot2c_f32_bf16 v58, v129, v76
    v_dot2c_f32_bf16 v59, v129, v77
    v_dot2c_f32_bf16 v60, v130, v76
    v_dot2c_f32_bf16 v61, v130, v77
L_rp_c7:
    s_cmp_eq_u32 s73, 0
    s_cbranch_scc1 L_rp_ok
    s_add_u32 s74, s74, 1
    s_cmp_lt_u32 s74, 800000
    s_cbranch_scc1 L_rp_retry
L_rp_ok:
    s_cmp_ge_u32 s3, 5
    ds_write_b128 v65, v[52:55] offset:36992
    ds_write_b128 v65, v[56:59] offset:37008
    ds_write_b64 v66, v[60:61] offset:39040
    s_waitcnt lgkmcnt(0)
    s_barrier
    s_cbranch_scc1 L_epoch
    ds_read_b64 v[20:21], v67 offset:36992
    ds_read_b64 v[22:23], v67 offset:39552
    ds_read_b64 v[24:25], v67 offset:42112
    ds_read_b64 v[26:27], v67 offset:44672
    ds_read_b64 v[28:29], v67 offset:47232
    ds_read_b64 v[30:31], v67 offset:49792
    ds_read_b64 v[32:33], v67 offset:52352
    ds_read_b64 v[34:35], v67 offset:54912
    s_waitcnt lgkmcnt(0)
    v_pk_add_f32 v[20:21], v[20:21], v[28:29]
    v_pk_add_f32 v[22:23], v[22:23], v[30:31]
    v_pk_add_f32 v[24:25], v[24:25], v[32:33]
    v_pk_add_f32 v[26:27], v[26:27], v[34:35]
    v_pk_add_f32 v[20:21], v[20:21], v[24:25]
    v_pk_add_f32 v[22:23], v[22:23], v[26:27]
    v_pk_add_f32 v[20:21], v[20:21], v[22:23]
    v_cvt_pk_bf16_f32 v22, v20, v21
    v_lshlrev_b32 v20, 16, v22
    v_and_b32 v21, 0xffff0000, v22
    v_pk_add_f32 v[20:21], v[20:21], v[70:71]
    v_cvt_pk_bf16_f32 v22, v20, v21
    v_lshlrev_b32 v20, 16, v22
    v_and_b32 v21, 0xffff0000, v22
    v_mul_f32 v25, v20, v20
    v_add_f32 v24, v20, v21
    v_fmac_f32 v25, v21, v21
    s_nop 0
    v_add_f32_dpp v24, v24, v24 quad_perm:[1,0,3,2] row_mask:0xf bank_mask:0xf
    v_add_f32_dpp v25, v25, v25 quad_perm:[1,0,3,2] row_mask:0xf bank_mask:0xf
    s_nop 0
    v_add_f32_dpp v24, v24, v24 quad_perm:[2,3,0,1] row_mask:0xf bank_mask:0xf
    v_add_f32_dpp v25, v25, v25 quad_perm:[2,3,0,1] row_mask:0xf bank_mask:0xf
    s_nop 0
    v_add_f32_dpp v24, v24, v24 row_half_mirror row_mask:0xf bank_mask:0xf
    v_add_f32_dpp v25, v25, v25 row_half_mirror row_mask:0xf bank_mask:0xf
    s_nop 0
    v_add_f32_dpp v24, v24, v24 row_mirror row_mask:0xf bank_mask:0xf
    v_add_f32_dpp v25, v25, v25 row_mirror row_mask:0xf bank_mask:0xf
    s_nop 0
    v_add_f32_dpp v24, v24, v24 row_bcast:15 row_mask:0xa bank_mask:0xf
    v_add_f32_dpp v25, v25, v25 row_bcast:15 row_mask:0xa bank_mask:0xf
    s_nop 0
    v_add_f32_dpp v24, v24, v24 row_bcast:31 row_mask:0xc bank_mask:0xf
    v_add_f32_dpp v25, v25, v25 row_bcast:31 row_mask:0xc bank_mask:0xf
    s_mov_b32 exec_lo, 0
    s_mov_b32 exec_hi, 0x80000000
    ds_write_b64 v68, v[24:25] offset:13120
    s_mov_b64 exec, -1
    s_waitcnt lgkmcnt(0)
    s_barrier
    ds_read_b128 v[28:31], v12 offset:13120
    ds_read_b128 v[32:35], v12 offset:13136
    ds_read_b64 v[36:37], v12 offset:13152
    s_waitcnt lgkmcnt(0)
    v_pk_add_f32 v[28:29], v[28:29], v[30:31]
    v_pk_add_f32 v[32:33], v[32:33], v[34:35]
    v_pk_add_f32 v[28:29], v[28:29], v[36:37]
    v_pk_add_f32 v[28:29], v[28:29], v[32:33]
    v_mul_f32 v28, 0x3acccccd, v28
    v_mul_f32 v29, 0x3acccccd, v29
    v_fma_f32 v29, -v28, v28, v29
    v_cvt_pk_bf16_f32 v30, v28, v28
    v_max_f32 v29, 0, v29
    v_and_b32 v30, 0xffff0000, v30
    v_mov_b32 v31, v29
    v_cvt_pk_bf16_f32 v31, v31, v31
    v_and_b32 v31, 0xffff0000, v31
    v_add_f32 v31, 0x3727c5ac, v31
    v_cvt_pk_bf16_f32 v31, v31, v31
    v_and_b32 v31, 0xffff0000, v31
    v_sqrt_f32 v31, v31
    s_nop 0
    v_cvt_pk_bf16_f32 v31, v31, v31
    v_and_b32 v31, 0xffff0000, v31
    v_rcp_f32 v31, v31
    v_sub_f32 v32, v20, v30
    v_sub_f32 v33, v21, v30
    v_sub_f32 v28, v28, v30
    v_mul_f32 v29, v29, v31
    v_mul_f32 v28, v28, v31
    v_mul_f32 v29, v29, v31
    v_cvt_pk_bf16_f32 v30, v32, v33
    v_lshlrev_b32 v32, 16, v30
    v_and_b32 v33, 0xffff0000, v30
    v_cvt_pk_bf16_f32 v28, v28, v28
    v_and_b32 v28, 0xffff0000, v28
    v_cvt_pk_bf16_f32 v29, v29, v29
    v_and_b32 v29, 0xffff0000, v29
    v_add_f32 v29, 0x3727c5ac, v29
    v_cvt_pk_bf16_f32 v29, v29, v29
    v_and_b32 v29, 0xffff0000, v29
    v_sqrt_f32 v29, v29
    s_nop 0
    v_cvt_pk_bf16_f32 v29, v29, v29
    v_and_b32 v29, 0xffff0000, v29
    v_rcp_f32 v29, v29
    v_mul_f32 v32, v32, v31
    v_mul_f32 v33, v33, v31
    v_cvt_pk_bf16_f32 v30, v32, v33
    v_lshlrev_b32 v32, 16, v30
    v_and_b32 v33, 0xffff0000, v30
    v_sub_f32 v32, v32, v28
    v_sub_f32 v33, v33, v28
    v_cvt_pk_bf16_f32 v30, v32, v33
    v_lshlrev_b32 v32, 16, v30
    v_and_b32 v33, 0xffff0000, v30
    v_mul_f32 v32, v32, v29
    v_mul_f32 v33, v33, v29
    v_cvt_pk_bf16_f32 v34, v32, v33
    v_and_b32 v32, 0x7fff, v34
    v_bfe_u32 v33, v34, 16, 15
    v_bfe_u32 v30, v34, 15, 1
    v_lshrrev_b32 v31, 31, v34
    v_subrev_u32 v36, 13824, v32
    v_subrev_u32 v37, 13824, v33
    v_cmp_lt_u32 s[66:67], v36, v69
    v_cmp_lt_u32 s[68:69], v37, v69
    v_mad_u32_u24 v36, v30, v74, v36
    v_mad_u32_u24 v37, v31, v74, v37
    v_cndmask_b32 v36, v75, v36, s[66:67]
    v_cndmask_b32 v37, v75, v37, s[68:69]
    v_lshlrev_b32 v36, 2, v36
    v_lshlrev_b32 v37, 2, v37
    ds_read_b32 v72, v36 offset:57472
    ds_read_b32 v73, v37 offset:57472
    v_cmp_eq_u32 s[70:71], 0, v32
    v_cmp_eq_u32 vcc, 0, v33
    s_or_b64 s[66:67], s[66:67], s[70:71]
    s_or_b64 s[68:69], s[68:69], vcc
    s_and_b64 s[70:71], s[66:67], s[68:69]
    s_cmp_eq_u64 s[70:71], -1
    s_waitcnt lgkmcnt(0)
    s_cbranch_scc0 L_fb
L_fin:
    v_pk_add_f32 v[20:21], v[20:21], v[72:73]
    v_cvt_pk_bf16_f32 v20, v20, v21
    global_store_dword v78, v20, s[24:25]
    s_endpgm
L_epoch:
    s_cmp_lg_u32 s61, 0
    s_cbranch_scc1 L_end
    s_cmp_lg_u32 s3, 7
    s_cbranch_scc1 L_end
    s_add_u32 s96, s96, 1
    s_addc_u32 s97, s97, 0
    v_mov_b32 v22, s96
    v_mov_b32 v23, s97
    s_mov_b32 s66, 393216
    s_mov_b64 exec, 1
    buffer_store_dwordx2 v[22:23], v12, s[48:51], s66 offen sc1
    s_endpgm
L_fb:
    s_load_dword s75, s[22:23], 0
    s_waitcnt lgkmcnt(0)
    s_lshl_b32 s75, s75, 16
    s_not_b64 s[66:67], s[66:67]
L_fb_next0:
    s_cmp_eq_u64 s[66:67], 0
    s_cbranch_scc1 L_fb_done0
    s_ff1_i32_b64 s72, s[66:67]
    s_bitset0_b64 s[66:67], s72
    v_readlane_b32 s73, v34, s72
    v_lshlrev_b32 v40, 1, v0
    v_mov_b32 v41, 0
    s_lshl_b32 s73, s73, 16
    s_mov_b32 s74, 0
L_fb_loop0:
    global_load_ushort v42, v40, s[16:17]
    global_load_ushort v43, v40, s[18:19]
    global_load_ushort v44, v40, s[20:21]
    v_add_u32 v40, 128, v40
    s_waitcnt vmcnt(0)
    v_lshlrev_b32 v42, 16, v42
    v_lshlrev_b32 v43, 16, v43
    v_lshlrev_b32 v44, 16, v44
    v_mul_f32 v42, s73, v42
    v_cvt_pk_bf16_f32 v42, v42, v42
    v_and_b32 v42, 0xffff0000, v42
    v_add_f32 v42, v42, v43
    v_cvt_pk_bf16_f32 v42, v42, v42
    v_and_b32 v42, 0xffff0000, v42
    v_mul_f32 v43, v42, v42
    v_mov_b32 v45, 0xc0135761
    v_fmac_f32 v45, 0xbdd2d3e8, v43
    v_mul_f32 v45, v45, v42
    v_exp_f32 v45, v45
    s_nop 0
    v_add_f32 v45, 1.0, v45
    v_rcp_f32 v45, v45
    s_nop 0
    v_mul_f32 v42, v42, v45
    v_cvt_pk_bf16_f32 v42, v42, v42
    v_and_b32 v42, 0xffff0000, v42
    v_fmac_f32 v41, v42, v44
    s_add_u32 s74, s74, 1
    s_cmp_lt_u32 s74, 24
    s_cbranch_scc1 L_fb_loop0
    s_nop 1
    v_add_f32_dpp v41, v41, v41 quad_perm:[1,0,3,2] row_mask:0xf bank_mask:0xf
    s_nop 1
    v_add_f32_dpp v41, v41, v41 quad_perm:[2,3,0,1] row_mask:0xf bank_mask:0xf
    s_nop 1
    v_add_f32_dpp v41, v41, v41 row_half_mirror row_mask:0xf bank_mask:0xf
    s_nop 1
    v_add_f32_dpp v41, v41, v41 row_mirror row_mask:0xf bank_mask:0xf
    s_nop 1
    v_add_f32_dpp v41, v41, v41 row_bcast:15 row_mask:0xa bank_mask:0xf
    s_nop 1
    v_add_f32_dpp v41, v41, v41 row_bcast:31 row_mask:0xc bank_mask:0xf
    v_cvt_pk_bf16_f32 v41, v41, v41
    v_and_b32 v41, 0xffff0000, v41
    v_add_f32 v41, s75, v41
    v_cvt_pk_bf16_f32 v41, v41, v41
    v_and_b32 v41, 0xffff0000, v41
    s_nop 0
    v_readlane_b32 s73, v41, 63
    s_mov_b32 m0, s72
    s_nop 1
    v_writelane_b32 v72, s73, m0
    s_branch L_fb_next0
L_fb_done0:
    s_not_b64 s[68:69], s[68:69]
L_fb_next1:
    s_cmp_eq_u64 s[68:69], 0
    s_cbranch_scc1 L_fb_done1
    s_ff1_i32_b64 s72, s[68:69]
    s_bitset0_b64 s[68:69], s72
    v_readlane_b32 s73, v34, s72
    v_lshlrev_b32 v40, 1, v0
    v_mov_b32 v41, 0
    s_and_b32 s73, s73, 0xffff0000
    s_mov_b32 s74, 0
L_fb_loop1:
    global_load_ushort v42, v40, s[16:17]
    global_load_ushort v43, v40, s[18:19]
    global_load_ushort v44, v40, s[20:21]
    v_add_u32 v40, 128, v40
    s_waitcnt vmcnt(0)
    v_lshlrev_b32 v42, 16, v42
    v_lshlrev_b32 v43, 16, v43
    v_lshlrev_b32 v44, 16, v44
    v_mul_f32 v42, s73, v42
    v_cvt_pk_bf16_f32 v42, v42, v42
    v_and_b32 v42, 0xffff0000, v42
    v_add_f32 v42, v42, v43
    v_cvt_pk_bf16_f32 v42, v42, v42
    v_and_b32 v42, 0xffff0000, v42
    v_mul_f32 v43, v42, v42
    v_mov_b32 v45, 0xc0135761
    v_fmac_f32 v45, 0xbdd2d3e8, v43
    v_mul_f32 v45, v45, v42
    v_exp_f32 v45, v45
    s_nop 0
    v_add_f32 v45, 1.0, v45
    v_rcp_f32 v45, v45
    s_nop 0
    v_mul_f32 v42, v42, v45
    v_cvt_pk_bf16_f32 v42, v42, v42
    v_and_b32 v42, 0xffff0000, v42
    v_fmac_f32 v41, v42, v44
    s_add_u32 s74, s74, 1
    s_cmp_lt_u32 s74, 24
    s_cbranch_scc1 L_fb_loop1
    s_nop 1
    v_add_f32_dpp v41, v41, v41 quad_perm:[1,0,3,2] row_mask:0xf bank_mask:0xf
    s_nop 1
    v_add_f32_dpp v41, v41, v41 quad_perm:[2,3,0,1] row_mask:0xf bank_mask:0xf
    s_nop 1
    v_add_f32_dpp v41, v41, v41 row_half_mirror row_mask:0xf bank_mask:0xf
    s_nop 1
    v_add_f32_dpp v41, v41, v41 row_mirror row_mask:0xf bank_mask:0xf
    s_nop 1
    v_add_f32_dpp v41, v41, v41 row_bcast:15 row_mask:0xa bank_mask:0xf
    s_nop 1
    v_add_f32_dpp v41, v41, v41 row_bcast:31 row_mask:0xc bank_mask:0xf
    v_cvt_pk_bf16_f32 v41, v41, v41
    v_and_b32 v41, 0xffff0000, v41
    v_add_f32 v41, s75, v41
    v_cvt_pk_bf16_f32 v41, v41, v41
    v_and_b32 v41, 0xffff0000, v41
    s_nop 0
    v_readlane_b32 s73, v41, 63
    s_mov_b32 m0, s72
    s_nop 1
    v_writelane_b32 v73, s73, m0
    s_branch L_fb_next1
L_fb_done1:
    s_branch L_fin
L_end:
    s_endpgm
.section .rodata,"a"
.p2align 6
.amdhsa_kernel sequential_preLN__mha_block_cached__mixer_token_mlp__decode_kernel
  .amdhsa_next_free_vgpr 256
  .amdhsa_next_free_sgpr 102
  .amdhsa_accum_offset 136
  .amdhsa_group_segment_fixed_size 0
  .amdhsa_kernarg_size 104
  .amdhsa_user_sgpr_count 2
  .amdhsa_user_sgpr_kernarg_segment_ptr 1
  .amdhsa_system_sgpr_workgroup_id_x 1
  .amdhsa_float_denorm_mode_32 3
  .amdhsa_float_denorm_mode_16_64 3
.end_amdhsa_kernel
```
